```python
import torch

def _softmax(x, axis=-1):
    return torch.softmax(x, dim=axis)
def _gelu(x):
    return torch.nn.functional.gelu(x, approximate="tanh")
def _silu(x):
    return torch.nn.functional.silu(x)
def _sigmoid(x):
    return torch.sigmoid(x)
def _layernorm(x, axis=-1, eps=1e-5):
    m = x.mean(dim=axis, keepdim=True)
    v = x.var(dim=axis, keepdim=True, unbiased=False)
    return (x - m) / torch.sqrt(v + eps)
def _scatter_add(tgt, idx, src, axis=0):
    return tgt.clone().index_add_(axis, idx, src)
def _segment_sum(src, seg, n):
    out = torch.zeros((n,) + src.shape[1:], dtype=src.dtype)
    return out.index_add_(0, seg, src)
def _pad(x, pw):
    flat = tuple(v for pair in reversed(pw) for v in pair)
    return torch.nn.functional.pad(x, flat)

kernel_name = 'sequential_preLN__spectral_gfnet__geglu_ffn__prompt'

def setup_inputs():

    _w = (lambda a: (lambda t: t.to(torch.bfloat16) if t.is_floating_point() else t)(torch.as_tensor(a)))
    def _A_setup():
        B, S, D = 1, 2048, 640
        Df = D // 2 + 1
        return {
            "x": _w((lambda *s: torch.randn(*s, dtype=torch.bfloat16) * 0.05)(B, S, D)),
            "w_r": _w((lambda *s: torch.randn(*s, dtype=torch.bfloat16) * 0.4)(S, Df) * 0.02),
            "w_i": _w((lambda *s: torch.randn(*s, dtype=torch.bfloat16) * 0.4)(S, Df) * 0.02),
        }
    _A_in = _A_setup()

    def _B_setup():
        B, S, D, F = 1, 2048, 640, 1728
        return {
            "x": _w((lambda *s: torch.randn(*s, dtype=torch.bfloat16) * 0.05)(B, S, D)),
            "w_gate": _w((lambda *s: torch.randn(*s, dtype=torch.bfloat16) * 0.05)(D, F)),
            "w_up": _w((lambda *s: torch.randn(*s, dtype=torch.bfloat16) * 0.05)(D, F)),
            "w_down": _w((lambda *s: torch.randn(*s, dtype=torch.bfloat16) * 0.05)(F, D)),
        }
    _B_in = _B_setup()

    return {
        "A_x": _A_in["x"],
        "A_w_r": _A_in["w_r"],
        "A_w_i": _A_in["w_i"],
        "B_x": _B_in["x"],
        "B_w_gate": _B_in["w_gate"],
        "B_w_up": _B_in["w_up"],
        "B_w_down": _B_in["w_down"],
    }

def reference(A_x, A_w_r, A_w_i, B_x, B_w_gate, B_w_up, B_w_down):
    def _A_ref(x, w_r, w_i):
        B, S, D = x.shape
        X = (lambda x, axes=(-2,-1): torch.fft.rfft2(x.float(), dim=axes))(x, axes=(-2, -1))
        W = w_r + 1j * w_i
        X = X * W
        y = (lambda x, s, axes=(-2,-1): torch.fft.irfft2(x, s=s, dim=axes).to(torch.bfloat16))(X, (S, D), axes=(-2, -1))
        return y

    def _B_ref(x, w_gate, w_up, w_down):
        return (_gelu(x @ w_gate) * (x @ w_up)) @ w_down

    x = A_x
    h = x + _A_ref(_layernorm(x, axis=-1), A_w_r, A_w_i)
    h2 = h + _B_ref(_layernorm(h, axis=-1), B_w_gate, B_w_up, B_w_down)
    return h2
```

```asm
; @launch kernel=k1_kernel grid=(256,1,1) block=(512,1,1) lds=22016
; @launch kernel=k2_kernel grid=(273,1,1) block=(256,1,1) lds=32768
; @launch kernel=k3_kernel grid=(256,1,1) block=(512,1,1) lds=147456
.amdgcn_target "amdgcn-amd-amdhsa--gfx950"
.text
.p2align 8
.type ctab3,@object
ctab3:
.long 0x80003400,0x80003400,0x80003400,0x80003400,0x80003400,0xae1f3364,0xb1a831a8,0xb3642e1f
.long 0x80003400,0xb1a831a8,0xb4000000,0xb1a8b1a8,0x80003400,0xb3642e1f,0xb1a8b1a8,0x2e1fb364
.long 0x80003400,0xb4000000,0x8000b400,0x34000000,0x80003400,0xb364ae1f,0x31a8b1a8,0x2e1f3364
.long 0x80003400,0xb1a8b1a8,0x34000000,0xb1a831a8,0x80003400,0xae1fb364,0x31a831a8,0xb364ae1f
.long 0x80003400,0x8000b400,0x80003400,0x8000b400,0x80003400,0x2e1fb364,0xb1a831a8,0x3364ae1f
.long 0x80003400,0x31a8b1a8,0xb4000000,0x31a831a8,0x80003400,0x3364ae1f,0xb1a8b1a8,0xae1f3364
.long 0x80003400,0x34000000,0x8000b400,0xb4000000,0x80003400,0x33642e1f,0x31a8b1a8,0xae1fb364
.long 0x80003400,0x31a831a8,0x34000000,0x31a8b1a8,0x80003400,0x2e1f3364,0x31a831a8,0x33642e1f
.long 0x80003400,0x80003400,0x80003400,0x80003400,0xb4000000,0xb364ae1f,0xb1a8b1a8,0xae1fb364
.long 0x8000b400,0x31a8b1a8,0x34000000,0x31a831a8,0x34000000,0x2e1f3364,0xb1a831a8,0xb364ae1f
.long 0x80003400,0xb4000000,0x8000b400,0x34000000,0xb4000000,0x2e1fb364,0x31a831a8,0xb3642e1f
.long 0x8000b400,0x31a831a8,0xb4000000,0x31a8b1a8,0x34000000,0xb3642e1f,0x31a8b1a8,0xae1f3364
.long 0x80003400,0x8000b400,0x80003400,0x8000b400,0xb4000000,0x33642e1f,0xb1a8b1a8,0x2e1f3364
.long 0x8000b400,0xb1a831a8,0x34000000,0xb1a8b1a8,0x34000000,0xae1fb364,0xb1a831a8,0x33642e1f
.long 0x80003400,0x34000000,0x8000b400,0xb4000000,0xb4000000,0xae1f3364,0x31a831a8,0x3364ae1f
.long 0x8000b400,0xb1a8b1a8,0xb4000000,0xb1a831a8,0x34000000,0x3364ae1f,0x31a8b1a8,0x2e1fb364
.long 0x80003400,0x80003400,0x80003400,0x80003400,0x8000b400,0x2e1fb364,0x31a8b1a8,0x3364ae1f
.long 0x80003400,0xb1a831a8,0xb4000000,0xb1a8b1a8,0x8000b400,0x3364ae1f,0x31a831a8,0xae1f3364
.long 0x80003400,0xb4000000,0x8000b400,0x34000000,0x8000b400,0x33642e1f,0xb1a831a8,0xae1fb364
.long 0x80003400,0xb1a8b1a8,0x34000000,0xb1a831a8,0x8000b400,0x2e1f3364,0xb1a8b1a8,0x33642e1f
.long 0x80003400,0x8000b400,0x80003400,0x8000b400,0x8000b400,0xae1f3364,0x31a8b1a8,0xb3642e1f
.long 0x80003400,0x31a8b1a8,0xb4000000,0x31a831a8,0x8000b400,0xb3642e1f,0x31a831a8,0x2e1fb364
.long 0x80003400,0x34000000,0x8000b400,0xb4000000,0x8000b400,0xb364ae1f,0xb1a831a8,0x2e1f3364
.long 0x80003400,0x31a831a8,0x34000000,0x31a8b1a8,0x8000b400,0xae1fb364,0xb1a8b1a8,0xb364ae1f
.long 0x80003400,0x80003400,0x80003400,0x80003400,0x34000000,0x33642e1f,0x31a831a8,0x2e1f3364
.long 0x8000b400,0x31a8b1a8,0x34000000,0x31a831a8,0xb4000000,0xae1fb364,0x31a8b1a8,0x33642e1f
.long 0x80003400,0xb4000000,0x8000b400,0x34000000,0x34000000,0xae1f3364,0xb1a8b1a8,0x3364ae1f
.long 0x8000b400,0x31a831a8,0xb4000000,0x31a8b1a8,0xb4000000,0x3364ae1f,0xb1a831a8,0x2e1fb364
.long 0x80003400,0x8000b400,0x80003400,0x8000b400,0x34000000,0xb364ae1f,0x31a831a8,0xae1fb364
.long 0x8000b400,0xb1a831a8,0x34000000,0xb1a8b1a8,0xb4000000,0x2e1f3364,0x31a8b1a8,0xb364ae1f
.long 0x80003400,0x34000000,0x8000b400,0xb4000000,0x34000000,0x2e1fb364,0xb1a8b1a8,0xb3642e1f
.long 0x8000b400,0xb1a8b1a8,0xb4000000,0xb1a831a8,0xb4000000,0xb3642e1f,0xb1a831a8,0xae1f3364
.long 0x34000000,0x34000000,0x34000000,0x34000000,0x34000000,0x33642e1f,0x31a831a8,0x2e1f3364
.long 0x34000000,0x31a831a8,0x3400,0xb1a831a8,0x34000000,0x2e1f3364,0xb1a831a8,0xb364ae1f
.long 0x34000000,0x3400,0xb4000000,0xb400,0x34000000,0xae1f3364,0xb1a8b1a8,0x3364ae1f
.long 0x34000000,0xb1a831a8,0xb400,0x31a831a8,0x34000000,0xb3642e1f,0x31a8b1a8,0xae1f3364
.long 0x34000000,0xb4000000,0x34000000,0xb4000000,0x34000000,0xb364ae1f,0x31a831a8,0xae1fb364
.long 0x34000000,0xb1a8b1a8,0x3400,0x31a8b1a8,0x34000000,0xae1fb364,0xb1a831a8,0x33642e1f
.long 0x34000000,0xb400,0xb4000000,0x3400,0x34000000,0x2e1fb364,0xb1a8b1a8,0xb3642e1f
.long 0x34000000,0x31a8b1a8,0xb400,0xb1a8b1a8,0x34000000,0x3364ae1f,0x31a8b1a8,0x2e1fb364
.long 0x34000000,0x34000000,0x34000000,0x34000000,0x3400,0xae1f3364,0xb1a831a8,0xb3642e1f
.long 0xb4000000,0xb1a8b1a8,0xb400,0x31a8b1a8,0xb400,0x3364ae1f,0x31a831a8,0xae1f3364
.long 0x34000000,0x3400,0xb4000000,0xb400,0x3400,0xb364ae1f,0x31a8b1a8,0x2e1f3364
.long 0xb4000000,0x31a8b1a8,0x3400,0xb1a8b1a8,0xb400,0x2e1f3364,0xb1a8b1a8,0x33642e1f
.long 0x34000000,0xb4000000,0x34000000,0xb4000000,0x3400,0x2e1fb364,0xb1a831a8,0x3364ae1f
.long 0xb4000000,0x31a831a8,0xb400,0xb1a831a8,0xb400,0xb3642e1f,0x31a831a8,0x2e1fb364
.long 0x34000000,0xb400,0xb4000000,0x3400,0x3400,0x33642e1f,0x31a8b1a8,0xae1fb364
.long 0xb4000000,0xb1a831a8,0x3400,0x31a831a8,0xb400,0xae1fb364,0xb1a8b1a8,0xb364ae1f
.long 0x34000000,0x34000000,0x34000000,0x34000000,0xb4000000,0xb364ae1f,0xb1a8b1a8,0xae1fb364
.long 0x34000000,0x31a831a8,0x3400,0xb1a831a8,0xb4000000,0xae1fb364,0x31a8b1a8,0x33642e1f
.long 0x34000000,0x3400,0xb4000000,0xb400,0xb4000000,0x2e1fb364,0x31a831a8,0xb3642e1f
.long 0x34000000,0xb1a831a8,0xb400,0x31a831a8,0xb4000000,0x3364ae1f,0xb1a831a8,0x2e1fb364
.long 0x34000000,0xb4000000,0x34000000,0xb4000000,0xb4000000,0x33642e1f,0xb1a8b1a8,0x2e1f3364
.long 0x34000000,0xb1a8b1a8,0x3400,0x31a8b1a8,0xb4000000,0x2e1f3364,0x31a8b1a8,0xb364ae1f
.long 0x34000000,0xb400,0xb4000000,0x3400,0xb4000000,0xae1f3364,0x31a831a8,0x3364ae1f
.long 0x34000000,0x31a8b1a8,0xb400,0xb1a8b1a8,0xb4000000,0xb3642e1f,0xb1a831a8,0xae1f3364
.long 0x34000000,0x34000000,0x34000000,0x34000000,0xb400,0x2e1fb364,0x31a8b1a8,0x3364ae1f
.long 0xb4000000,0xb1a8b1a8,0xb400,0x31a8b1a8,0x3400,0xb3642e1f,0xb1a8b1a8,0x2e1fb364
.long 0x34000000,0x3400,0xb4000000,0xb400,0xb400,0x33642e1f,0xb1a831a8,0xae1fb364
.long 0xb4000000,0x31a8b1a8,0x3400,0xb1a8b1a8,0x3400,0xae1fb364,0x31a831a8,0xb364ae1f
.long 0x34000000,0xb4000000,0x34000000,0xb4000000,0xb400,0xae1f3364,0x31a8b1a8,0xb3642e1f
.long 0xb4000000,0x31a831a8,0xb400,0xb1a831a8,0x3400,0x3364ae1f,0xb1a8b1a8,0xae1f3364
.long 0x34000000,0xb400,0xb4000000,0x3400,0xb400,0xb364ae1f,0xb1a831a8,0x2e1f3364
.long 0xb4000000,0xb1a831a8,0x3400,0x31a831a8,0x3400,0x2e1f3364,0x31a831a8,0x33642e1f
.long 0x3f800000,0x3f800000,0x3f800000,0x3f800000,0x3f800000,0x3f7ff35e,0x3f7fcd79,0x3f7f8e56
.long 0x3f800000,0x3f7fcd79,0x3f7f35f9,0x3f7e39bc,0x3f800000,0x3f7f8e56,0x3f7e39bc,0x3f7c0361
.long 0x3f800000,0x3f7f35f9,0x3f7cd925,0x3f78ed3c,0x3f800000,0x3f7ec46d,0x3f7b14be,0x3f74fa0b
.long 0x3f800000,0x3f7e39bc,0x3f78ed3c,0x3f702d4f,0x3f800000,0x3f7d95f4,0x3f766377,0x3f6a8b4b
.long 0x3f800000,0x3f7cd925,0x3f737871,0x3f641901,0x3f800000,0x3f7c0361,0x3f702d4f,0x3f5cdc29
.long 0x3f800000,0x3f7b14be,0x3f6c835e,0x3f54db31,0x3f800000,0x3f7a0d54,0x3f687c12,0x3f4c1d35
.long 0x3f800000,0x3f78ed3c,0x3f641901,0x3f42a9f7,0x3f800000,0x3f77b493,0x3f5f5be6,0x3f3889dc
.long 0x3f800000,0x3f766377,0x3f5a46a0,0x3f2dc5e3,0x3f800000,0x3f74fa0b,0x3f54db31,0x3f226799
.long 0x3f800000,0x3f800000,0x3f800000,0x3f800000,0x3f7f35f9,0x3f7ec46d,0x3f7e39bc,0x3f7d95f4
.long 0x3f7cd925,0x3f7b14be,0x3f78ed3c,0x3f766377,0x3f78ed3c,0x3f74fa0b,0x3f702d4f,0x3f6a8b4b
.long 0x3f737871,0x3f6c835e,0x3f641901,0x3f5a46a0,0x3f6c835e,0x3f61c598,0x3f54db31,0x3f45e403
.long 0x3f641901,0x3f54db31,0x3f42a9f7,0x3f2dc5e3,0x3f5a46a0,0x3f45e403,0x3f2dc5e3,0x3f1260b2
.long 0x3f4f1bbd,0x3f3504f3,0x3f167918,0x3ee87171,0x3f42a9f7,0x3f226799,0x3efa2c90,0x3ea7bf25
.long 0x3f3504f3,0x3f0e39da,0x3ec3ef15,0x3e47c5c2,0x3f26423a,0x3ef15aea,0x3e8afa3e,0x3d712283
.long 0x3f167918,0x3ec3ef15,0x3e20305b,0xbda0af2a,0x3f05c277,0x3e94a031,0x3d20cee7,0xbe5b73dc
.long 0x3ee87171,0x3e47c5c2,0xbda0af2a,0xbeb13641,0x3ec3ef15,0x3dc8bd36,0xbe47c5c2,0xbef15aea
.long 0x3f800000,0x3f800000,0x3f800000,0x3f800000,0x3f7cd925,0x3f7c0361,0x3f7b14be,0x3f7a0d54
.long 0x3f737871,0x3f702d4f,0x3f6c835e,0x3f687c12,0x3f641901,0x3f5cdc29,0x3f54db31,0x3f4c1d35
.long 0x3f4f1bbd,0x3f42a9f7,0x3f3504f3,0x3f26423a,0x3f3504f3,0x3f226799,0x3f0e39da,0x3ef15aea
.long 0x3f167918,0x3efa2c90,0x3ec3ef15,0x3e8afa3e,0x3ee87171,0x3ea7bf25,0x3e47c5c2,0x3d712283
.long 0x3e9e377a,0x3e20305b,0x0,0xbe20305b,0x3e20305b,0xbca0d6d6,0xbe47c5c2,0xbeba9be1
.long 0x0,0xbe47c5c2,0xbec3ef15,0xbf0e39da,0xbe20305b,0xbeba9be1,0xbf0e39da,0xbf3889dc
.long 0xbe9e377a,0xbf05c277,0xbf3504f3,0xbf5a46a0,0xbee87171,0xbf2a0c73,0xbf54db31,0xbf71decf
.long 0xbf167918,0xbf490a88,0xbf6c835e,0xbf7e39bc,0xbf3504f3,0xbf61c598,0xbf7b14be,0xbf7ec46d
.long 0x3f800000,0x3f800000,0x3f800000,0x3f800000,0x3f78ed3c,0x3f77b493,0x3f766377,0x3f74fa0b
.long 0x3f641901,0x3f5f5be6,0x3f5a46a0,0x3f54db31,0x3f42a9f7,0x3f3889dc,0x3f2dc5e3,0x3f226799
.long 0x3f167918,0x3f05c277,0x3ee87171,0x3ec3ef15,0x3ec3ef15,0x3e94a031,0x3e47c5c2,0x3dc8bd36
.long 0x3e20305b,0x3d20cee7,0xbda0af2a,0xbe47c5c2,0xbda0af2a,0xbe5b73dc,0xbeb13641,0xbef15aea
.long 0xbe9e377a,0xbee87171,0xbf167918,0xbf3504f3,0xbf05c277,0xbf2a0c73,0xbf490a88,0xbf61c598
.long 0xbf3504f3,0xbf54db31,0xbf6c835e,0xbf7b14be,0xbf5a46a0,0xbf71decf,0xbf7e39bc,0xbf7ec46d
.long 0xbf737871,0xbf7f35f9,0xbf7cd925,0xbf6c835e,0xbf7f35f9,0xbf7c0361,0xbf687c12,0xbf45e403
.long 0xbf7cd925,0xbf687c12,0xbf42a9f7,0xbf0e39da,0xbf6c835e,0xbf45e403,0xbf0e39da,0xbe94a031
.long 0x3f800000,0x3f800000,0x3f800000,0x3f800000,0x3f737871,0x3f71decf,0x3f702d4f,0x3f6e641a
.long 0x3f4f1bbd,0x3f490a88,0x3f42a9f7,0x3f3bfc8f,0x3f167918,0x3f0a04f8,0x3efa2c90,0x3edf7108
.long 0x3e9e377a,0x3e6f0c4d,0x3e20305b,0x3da0af2a,0x0,0xbdc8bd36,0xbe47c5c2,0xbe94a031
.long 0xbe9e377a,0xbed65a92,0xbf05c277,0xbf1e7cf1,0xbf167918,0xbf316e2c,0xbf490a88,0xbf5cdc29
.long 0xbf4f1bbd,0xbf641901,0xbf737871,0xbf7cd925,0xbf737871,0xbf7d95f4,0xbf7fcd79,0xbf7a0d54
.long 0xbf800000,0xbf7b14be,0xbf6c835e,0xbf54db31,0xbf737871,0xbf5cdc29,0xbf3bfc8f,0xbf1260b2
.long 0xbf4f1bbd,0xbf26423a,0xbee87171,0xbe6f0c4d,0xbf167918,0xbeba9be1,0xbdf0b772,0x3e0c4cf7
.long 0xbe9e377a,0xbd20cee7,0x3e6f0c4d,0x3efa2c90,0x0,0x3e94a031,0x3f0e39da,0x3f45e403
.long 0x3f800000,0x3f800000,0x3f800000,0x3f800000,0x3f6c835e,0x3f6a8b4b,0x3f687c12,0x3f6655e7
.long 0x3f3504f3,0x3f2dc5e3,0x3f26423a,0x3f1e7cf1,0x3ec3ef15,0x3ea7bf25,0x3e8afa3e,0x3e5b73dc
.long 0x0,0xbda0af2a,0xbe20305b,0xbe6f0c4d,0xbec3ef15,0xbef15aea,0xbf0e39da,0xbf226799
.long 0xbf3504f3,0xbf490a88,0xbf5a46a0,0xbf687c12,0xbf6c835e,0xbf77b493,0xbf7e39bc,0xbf7ff35e
.long 0xbf800000,0xbf7cd925,0xbf737871,0xbf641901,0xbf6c835e,0xbf579b8c,0xbf3bfc8f,0xbf1a82a4
.long 0xbf3504f3,0xbf0e39da,0xbec3ef15,0xbe47c5c2,0xbec3ef15,0xbe3403f1,0x3d20cee7,0x3e814693
.long 0x0,0x3e6f0c4d,0x3ee87171,0x3f26423a,0x3ec3ef15,0x3f1a82a4,0x3f490a88,0x3f6a8b4b
.long 0x3f3504f3,0x3f5f5be6,0x3f78ed3c,0x3f7fcd79,0x3f6c835e,0x3f7ec46d,0x3f7b14be,0x3f61c598
.long 0x3f800000,0x3f800000,0x3f800000,0x3f800000,0x3f641901,0x3f61c598,0x3f5f5be6,0x3f5cdc29
.long 0x3f167918,0x3f0e39da,0x3f05c277,0x3efa2c90,0x3e20305b,0x3dc8bd36,0x3d20cee7,0xbca0d6d6
.long 0xbe9e377a,0xbec3ef15,0xbee87171,0xbf05c277,0xbf3504f3,0xbf45e403,0xbf54db31,0xbf61c598
.long 0xbf737871,0xbf7b14be,0xbf7f35f9,0xbf7fcd79,0xbf7cd925,0xbf74fa0b,0xbf687c12,0xbf579b8c
.long 0xbf4f1bbd,0xbf3504f3,0xbf167918,0xbee87171,0xbee87171,0xbe94a031,0xbdf0b772,0x3d712283
.long 0x0,0x3e47c5c2,0x3ec3ef15,0x3f0e39da,0x3ee87171,0x3f226799,0x3f490a88,0x3f6655e7
.long 0x3f4f1bbd,0x3f6c835e,0x3f7cd925,0x3f7f35f9,0x3f7cd925,0x3f7ec46d,0x3f702d4f,0x3f5205d4
.long 0x3f737871,0x3f54db31,0x3f26423a,0x3ed65a92,0x3f3504f3,0x3ef15aea,0x3e47c5c2,0xbdc8bd36
.long 0x3f800000,0x3f800000,0x3f800000,0x3f800000,0x3f5a46a0,0x3f579b8c,0x3f54db31,0x3f5205d4
.long 0x3ee87171,0x3ed65a92,0x3ec3ef15,0x3eb13641,0xbda0af2a,0xbe0c4cf7,0xbe47c5c2,0xbe814693
.long 0xbf167918,0xbf26423a,0xbf3504f3,0xbf42a9f7,0xbf6c835e,0xbf74fa0b,0xbf7b14be,0xbf7ec46d
.long 0xbf7cd925,0xbf766377,0xbf6c835e,0xbf5f5be6,0xbf42a9f7,0xbf2a0c73,0xbf0e39da,0xbedf7108
.long 0xbe9e377a,0xbe20305b,0x0,0x3e20305b,0x3e6f0c4d,0x3ecd2ef3,0x3f0e39da,0x3f316e2c
.long 0x3f3504f3,0x3f54db31,0x3f6c835e,0x3f7b14be,0x3f78ed3c,0x3f7ff35e,0x3f7b14be,0x3f6a8b4b
.long 0x3f737871,0x3f5a46a0,0x3f3504f3,0x3f05c277,0x3f26423a,0x3edf7108,0x3e47c5c2,0xbd712283
.long 0x3e20305b,0xbdf0b772,0xbec3ef15,0xbf1e7cf1,0xbec3ef15,0xbf226799,0xbf54db31,0xbf74fa0b
.long 0x0,0x0,0x0,0x0,0x0,0x3ca0d6d6,0x3d20cee7,0x3d712283
.long 0x0,0x3d20cee7,0x3da0af2a,0x3df0b772,0x0,0x3d712283,0x3df0b772,0x3e3403f1
.long 0x0,0x3da0af2a,0x3e20305b,0x3e6f0c4d,0x0,0x3dc8bd36,0x3e47c5c2,0x3e94a031
.long 0x0,0x3df0b772,0x3e6f0c4d,0x3eb13641,0x0,0x3e0c4cf7,0x3e8afa3e,0x3ecd2ef3
.long 0x0,0x3e20305b,0x3e9e377a,0x3ee87171,0x0,0x3e3403f1,0x3eb13641,0x3f0172c3
.long 0x0,0x3e47c5c2,0x3ec3ef15,0x3f0e39da,0x0,0x3e5b73dc,0x3ed65a92,0x3f1a82a4
.long 0x0,0x3e6f0c4d,0x3ee87171,0x3f26423a,0x0,0x3e814693,0x3efa2c90,0x3f316e2c
.long 0x0,0x3e8afa3e,0x3f05c277,0x3f3bfc8f,0x0,0x3e94a031,0x3f0e39da,0x3f45e403
.long 0x0,0x0,0x0,0x0,0x3da0af2a,0x3dc8bd36,0x3df0b772,0x3e0c4cf7
.long 0x3e20305b,0x3e47c5c2,0x3e6f0c4d,0x3e8afa3e,0x3e6f0c4d,0x3e94a031,0x3eb13641,0x3ecd2ef3
.long 0x3e9e377a,0x3ec3ef15,0x3ee87171,0x3f05c277,0x3ec3ef15,0x3ef15aea,0x3f0e39da,0x3f226799
.long 0x3ee87171,0x3f0e39da,0x3f26423a,0x3f3bfc8f,0x3f05c277,0x3f226799,0x3f3bfc8f,0x3f5205d4
.long 0x3f167918,0x3f3504f3,0x3f4f1bbd,0x3f641901,0x3f26423a,0x3f45e403,0x3f5f5be6,0x3f71decf
.long 0x3f3504f3,0x3f54db31,0x3f6c835e,0x3f7b14be,0x3f42a9f7,0x3f61c598,0x3f766377,0x3f7f8e56
.long 0x3f4f1bbd,0x3f6c835e,0x3f7cd925,0x3f7f35f9,0x3f5a46a0,0x3f74fa0b,0x3f7fcd79,0x3f7a0d54
.long 0x3f641901,0x3f7b14be,0x3f7f35f9,0x3f702d4f,0x3f6c835e,0x3f7ec46d,0x3f7b14be,0x3f61c598
.long 0x0,0x0,0x0,0x0,0x3e20305b,0x3e3403f1,0x3e47c5c2,0x3e5b73dc
.long 0x3e9e377a,0x3eb13641,0x3ec3ef15,0x3ed65a92,0x3ee87171,0x3f0172c3,0x3f0e39da,0x3f1a82a4
.long 0x3f167918,0x3f26423a,0x3f3504f3,0x3f42a9f7,0x3f3504f3,0x3f45e403,0x3f54db31,0x3f61c598
.long 0x3f4f1bbd,0x3f5f5be6,0x3f6c835e,0x3f766377,0x3f641901,0x3f71decf,0x3f7b14be,0x3f7f8e56
.long 0x3f737871,0x3f7cd925,0x3f800000,0x3f7cd925,0x3f7cd925,0x3f7ff35e,0x3f7b14be,0x3f6e641a
.long 0x3f800000,0x3f7b14be,0x3f6c835e,0x3f54db31,0x3f7cd925,0x3f6e641a,0x3f54db31,0x3f316e2c
.long 0x3f737871,0x3f5a46a0,0x3f3504f3,0x3f05c277,0x3f641901,0x3f3f5cb5,0x3f0e39da,0x3ea7bf25
.long 0x3f4f1bbd,0x3f1e7cf1,0x3ec3ef15,0x3df0b772,0x3f3504f3,0x3ef15aea,0x3e47c5c2,0xbdc8bd36
.long 0x0,0x0,0x0,0x0,0x3e6f0c4d,0x3e814693,0x3e8afa3e,0x3e94a031
.long 0x3ee87171,0x3efa2c90,0x3f05c277,0x3f0e39da,0x3f26423a,0x3f316e2c,0x3f3bfc8f,0x3f45e403
.long 0x3f4f1bbd,0x3f5a46a0,0x3f641901,0x3f6c835e,0x3f6c835e,0x3f74fa0b,0x3f7b14be,0x3f7ec46d
.long 0x3f7cd925,0x3f7fcd79,0x3f7f35f9,0x3f7b14be,0x3f7f35f9,0x3f7a0d54,0x3f702d4f,0x3f61c598
.long 0x3f737871,0x3f641901,0x3f4f1bbd,0x3f3504f3,0x3f5a46a0,0x3f3f5cb5,0x3f1e7cf1,0x3ef15aea
.long 0x3f3504f3,0x3f0e39da,0x3ec3ef15,0x3e47c5c2,0x3f05c277,0x3ea7bf25,0x3df0b772,0xbdc8bd36
.long 0x3e9e377a,0x3da0af2a,0xbe20305b,0xbec3ef15,0x3da0af2a,0xbe3403f1,0xbed65a92,0xbf226799
.long 0xbe20305b,0xbed65a92,0xbf26423a,0xbf54db31,0xbec3ef15,0xbf226799,0xbf54db31,0xbf74fa0b
.long 0x0,0x0,0x0,0x0,0x3e9e377a,0x3ea7bf25,0x3eb13641,0x3eba9be1
.long 0x3f167918,0x3f1e7cf1,0x3f26423a,0x3f2dc5e3,0x3f4f1bbd,0x3f579b8c,0x3f5f5be6,0x3f6655e7
.long 0x3f737871,0x3f78ed3c,0x3f7cd925,0x3f7f35f9,0x3f800000,0x3f7ec46d,0x3f7b14be,0x3f74fa0b
.long 0x3f737871,0x3f687c12,0x3f5a46a0,0x3f490a88,0x3f4f1bbd,0x3f3889dc,0x3f1e7cf1,0x3f0172c3
.long 0x3f167918,0x3ee87171,0x3e9e377a,0x3e20305b,0x3e9e377a,0x3e0c4cf7,0xbd20cee7,0xbe5b73dc
.long 0x0,0xbe47c5c2,0xbec3ef15,0xbf0e39da,0xbe9e377a,0xbf0172c3,0xbf2dc5e3,0xbf5205d4
.long 0xbf167918,0xbf42a9f7,0xbf641901,0xbf78ed3c,0xbf4f1bbd,0xbf6e641a,0xbf7e39bc,0xbf7d95f4
.long 0xbf737871,0xbf7fcd79,0xbf78ed3c,0xbf5f5be6,0xbf800000,0xbf74fa0b,0xbf54db31,0xbf226799
.long 0x0,0x0,0x0,0x0,0x3ec3ef15,0x3ecd2ef3,0x3ed65a92,0x3edf7108
.long 0x3f3504f3,0x3f3bfc8f,0x3f42a9f7,0x3f490a88,0x3f6c835e,0x3f71decf,0x3f766377,0x3f7a0d54
.long 0x3f800000,0x3f7f35f9,0x3f7cd925,0x3f78ed3c,0x3f6c835e,0x3f61c598,0x3f54db31,0x3f45e403
.long 0x3f3504f3,0x3f1e7cf1,0x3f05c277,0x3ed65a92,0x3ec3ef15,0x3e814693,0x3df0b772,0xbca0d6d6
.long 0x0,0xbe20305b,0xbe9e377a,0xbee87171,0xbec3ef15,0xbf0a04f8,0xbf2dc5e3,0xbf4c1d35
.long 0xbf3504f3,0xbf54db31,0xbf6c835e,0xbf7b14be,0xbf6c835e,0xbf7c0361,0xbf7fcd79,0xbf77b493
.long 0xbf800000,0xbf78ed3c,0xbf641901,0xbf42a9f7,0xbf6c835e,0xbf4c1d35,0xbf1e7cf1,0xbecd2ef3
.long 0xbf3504f3,0xbefa2c90,0xbe6f0c4d,0x3d20cee7,0xbec3ef15,0xbdc8bd36,0x3e47c5c2,0x3ef15aea
.long 0x0,0x0,0x0,0x0,0x3ee87171,0x3ef15aea,0x3efa2c90,0x3f0172c3
.long 0x3f4f1bbd,0x3f54db31,0x3f5a46a0,0x3f5f5be6,0x3f7cd925,0x3f7ec46d,0x3f7fcd79,0x3f7ff35e
.long 0x3f737871,0x3f6c835e,0x3f641901,0x3f5a46a0,0x3f3504f3,0x3f226799,0x3f0e39da,0x3ef15aea
.long 0x3e9e377a,0x3e47c5c2,0x3da0af2a,0xbd20cee7,0xbe20305b,0xbe94a031,0xbed65a92,0xbf0a04f8
.long 0xbf167918,0xbf3504f3,0xbf4f1bbd,0xbf641901,0xbf641901,0xbf74fa0b,0xbf7e39bc,0xbf7f8e56
.long 0xbf800000,0xbf7b14be,0xbf6c835e,0xbf54db31,0xbf641901,0xbf45e403,0xbf1e7cf1,0xbedf7108
.long 0xbf167918,0xbec3ef15,0xbe20305b,0x3da0af2a,0xbe20305b,0x3dc8bd36,0x3eb13641,0x3f1260b2
.long 0x3e9e377a,0x3f0e39da,0x3f42a9f7,0x3f687c12,0x3f3504f3,0x3f61c598,0x3f7b14be,0x3f7ec46d
.long 0x0,0x0,0x0,0x0,0x3f05c277,0x3f0a04f8,0x3f0e39da,0x3f1260b2
.long 0x3f641901,0x3f687c12,0x3f6c835e,0x3f702d4f,0x3f7f35f9,0x3f7d95f4,0x3f7b14be,0x3f77b493
.long 0x3f4f1bbd,0x3f42a9f7,0x3f3504f3,0x3f26423a,0x3ec3ef15,0x3e94a031,0x3e47c5c2,0x3dc8bd36
.long 0xbe20305b,0xbe8afa3e,0xbec3ef15,0xbefa2c90,0xbf26423a,0xbf3f5cb5,0xbf54db31,0xbf6655e7
.long 0xbf737871,0xbf7cd925,0xbf800000,0xbf7cd925,0xbf78ed3c,0xbf6a8b4b,0xbf54db31,0xbf3889dc
.long 0xbf3504f3,0xbf0e39da,0xbec3ef15,0xbe47c5c2,0xbe6f0c4d,0xbca0d6d6,0x3e47c5c2,0x3ecd2ef3
.long 0x3e9e377a,0x3f05c277,0x3f3504f3,0x3f5a46a0,0x3f42a9f7,0x3f6655e7,0x3f7b14be,0x3f7f8e56
.long 0x3f7cd925,0x3f7e39bc,0x3f6c835e,0x3f490a88,0x3f6c835e,0x3f45e403,0x3f0e39da,0x3e94a031
.long 0x3c003c00,0x3c003c00,0x3c003c00,0x3c003c00,0x3b9c3c00,0x38b43a79,0x38b434f2,0x3b9c3a79
.long 0x3a793c00,0xb4f234f2,0xb4f2ba79,0x3a7934f2,0x38b43c00,0xbb9cb4f2,0xbb9cba79,0x38b4b4f2
.long 0x3c00,0xbc00,0x3c00,0xbc00,0xb4f23c00,0x3a79ba79,0x3a7934f2,0xb4f2ba79
.long 0xb8b43c00,0x3b9cb4f2,0x3b9cba79,0xb8b4b4f2,0xba793c00,0x34f234f2,0x34f2ba79,0xba7934f2
.long 0xbc003c00,0xbc003c00,0xbc003c00,0xbc003c00,0xbb9c3c00,0xb8b43a79,0xb8b434f2,0xbb9c3a79
.long 0xba793c00,0x34f234f2,0x34f2ba79,0xba7934f2,0xb8b43c00,0x3b9cb4f2,0x3b9cba79,0xb8b4b4f2
.long 0x3c00,0xbc00,0x3c00,0xbc00,0x34f23c00,0xba79ba79,0xba7934f2,0x34f2ba79
.long 0x38b43c00,0xbb9cb4f2,0xbb9cba79,0x38b4b4f2,0x3a793c00,0xb4f234f2,0xb4f2ba79,0x3a7934f2
.long 0x3c003c00,0x3c003c00,0x0,0x0,0x34f2,0xb8b4b4f2,0x0,0x0
.long 0xbc00ba79,0xb4f2ba79,0x0,0x80000000,0xba79,0x3b9c3a79,0x0,0x80008000
.long 0x3c00,0xbc00,0x0,0x8000,0xbc0034f2,0x3a7934f2,0x80000000,0x8000
.long 0xba79,0xbb9c3a79,0x80000000,0x8000,0x3c00ba79,0x34f2ba79,0x80000000,0x0
.long 0xbc003c00,0xbc003c00,0x80000000,0x80000000,0x34f2,0x38b4b4f2,0x80000000,0x80000000
.long 0x3c00ba79,0x34f2ba79,0x80000000,0x0,0xba79,0xbb9c3a79,0x80000000,0x8000
.long 0x3c00,0xbc00,0x0,0x8000,0x3c0034f2,0xba7934f2,0x0,0x80008000
.long 0xba79,0x3b9c3a79,0x0,0x80008000,0xbc00ba79,0xb4f2ba79,0x0,0x80000000
.long 0x3c003c00,0x3c003c00,0x0,0x0,0xbb9cba79,0xbb9cbc00,0x0,0x80008000
.long 0x3a7934f2,0x3a793c00,0x80008000,0x80008000,0xb8b434f2,0xb8b4bc00,0x8000,0x0
.long 0x3c00,0xbc00,0x0,0x8000,0xb4f2ba79,0xb4f23c00,0x80000000,0x0
.long 0x38b434f2,0x38b4bc00,0x8000,0x80000000,0xba7934f2,0xba793c00,0x8000,0x8000
.long 0xbc003c00,0xbc003c00,0x80000000,0x80000000,0x3b9cba79,0x3b9cbc00,0x0,0x8000
.long 0xba7934f2,0xba793c00,0x8000,0x8000,0x38b434f2,0x38b4bc00,0x8000,0x80000000
.long 0x3c00,0xbc00,0x0,0x8000,0x34f2ba79,0x34f23c00,0x0,0x80000000
.long 0xb8b434f2,0xb8b4bc00,0x8000,0x0,0x3a7934f2,0x3a793c00,0x80008000,0x80008000
.long 0x3c003c00,0x3c003c00,0x0,0x0,0xb8b4ba79,0xb4f2,0x80008000,0x80008000
.long 0xb4f234f2,0xbc00ba79,0x0,0x0,0x3b9c34f2,0x3a79,0x80000000,0x80008000
.long 0x3c00,0xbc00,0x0,0x8000,0x3a79ba79,0xbc0034f2,0x80008000,0x80000000
.long 0xbb9c34f2,0x3a79,0x0,0x8000,0x34f234f2,0x3c00ba79,0x80000000,0x80000000
.long 0xbc003c00,0xbc003c00,0x80000000,0x80000000,0x38b4ba79,0xb4f2,0x8000,0x8000
.long 0x34f234f2,0x3c00ba79,0x80000000,0x80000000,0xbb9c34f2,0x3a79,0x0,0x8000
.long 0x3c00,0xbc00,0x0,0x8000,0xba79ba79,0x3c0034f2,0x8000,0x0
.long 0x3b9c34f2,0x3a79,0x80000000,0x80008000,0xb4f234f2,0xbc00ba79,0x0,0x0
.long 0x0,0x0,0x0,0x0,0x34f20000,0x3a7938b4,0xba79bb9c,0xb4f2b8b4
.long 0x38b40000,0x3b9c3b9c,0xbb9cb8b4,0xb8b4bb9c,0x3a790000,0x34f23b9c,0xb4f238b4,0xba79bb9c
.long 0x3c000000,0xbc000000,0x3c000000,0xbc000000,0x3b9c0000,0xb8b4b8b4,0x38b4bb9c,0xbb9c38b4
.long 0x3a790000,0x34f2bb9c,0xb4f2b8b4,0xba793b9c,0x38b40000,0x3b9cbb9c,0xbb9c38b4,0xb8b43b9c
.long 0x0,0x0,0x0,0x0,0xb4f20000,0xba7938b4,0x3a79bb9c,0x34f2b8b4
.long 0xb8b40000,0xbb9c3b9c,0x3b9cb8b4,0x38b4bb9c,0xba790000,0xb4f23b9c,0x34f238b4,0x3a79bb9c
.long 0xbc000000,0x3c000000,0xbc000000,0x3c000000,0xbb9c0000,0x38b4b8b4,0xb8b4bb9c,0x3b9c38b4
.long 0xba790000,0xb4f2bb9c,0x34f2b8b4,0x3a793b9c,0xb8b40000,0xbb9cbb9c,0x3b9c38b4,0x38b43b9c
.long 0x0,0x0,0x0,0x0,0x3c003b9c,0x3a793b9c,0x0,0x0
.long 0x38b4,0xbb9cb8b4,0x0,0x0,0xbc00b8b4,0x34f2b8b4,0x0,0x0
.long 0x3c000000,0xbc000000,0x0,0x80000000,0x3b9c,0x38b4bb9c,0x0,0x80008000
.long 0xbc0038b4,0x34f238b4,0x0,0x8000,0xb8b4,0xbb9c38b4,0x0,0x8000
.long 0x0,0x0,0x0,0x0,0xbc003b9c,0xba793b9c,0x80000000,0x80000000
.long 0x38b4,0x3b9cb8b4,0x80000000,0x80000000,0x3c00b8b4,0xb4f2b8b4,0x80000000,0x80000000
.long 0xbc000000,0x3c000000,0x80000000,0x0,0x3b9c,0xb8b4bb9c,0x80000000,0x8000
.long 0x3c0038b4,0xb4f238b4,0x80000000,0x80008000,0xb8b4,0x3b9c38b4,0x80000000,0x80008000
.long 0x0,0x0,0x0,0x0,0x34f238b4,0xb4f20000,0x0,0x0
.long 0xb8b4bb9c,0x38b40000,0x0,0x80008000,0x3a793b9c,0xba790000,0x80008000,0x8000
.long 0x3c000000,0xbc000000,0x0,0x80000000,0xbb9c38b4,0x3b9c0000,0x0,0x8000
.long 0x3a79bb9c,0xba790000,0x80000000,0x0,0xb8b43b9c,0x38b40000,0x8000,0x80000000
.long 0x0,0x0,0x0,0x0,0xb4f238b4,0x34f20000,0x80000000,0x80000000
.long 0x38b4bb9c,0xb8b40000,0x0,0x8000,0xba793b9c,0x3a790000,0x8000,0x80008000
.long 0xbc000000,0x3c000000,0x80000000,0x0,0x3b9c38b4,0xbb9c0000,0x0,0x80008000
.long 0xba79bb9c,0x3a790000,0x0,0x80000000,0x38b43b9c,0xb8b40000,0x8000,0x0
.long 0x0,0x0,0x0,0x0,0xba79b8b4,0xbc00bb9c,0x0,0x80000000
.long 0x3b9c3b9c,0x38b4,0x80008000,0x0,0xb4f2bb9c,0x3c0038b4,0x0,0x80000000
.long 0x3c000000,0xbc000000,0x0,0x80000000,0xb8b4b8b4,0x3b9c,0x80000000,0x0
.long 0xb4f23b9c,0x3c00b8b4,0x8000,0x80000000,0x3b9cbb9c,0xb8b4,0x80000000,0x0
.long 0x0,0x0,0x0,0x0,0x3a79b8b4,0x3c00bb9c,0x80000000,0x0
.long 0xbb9c3b9c,0x38b4,0x8000,0x80000000,0x34f2bb9c,0xbc0038b4,0x80000000,0x0
.long 0xbc000000,0x3c000000,0x80000000,0x0,0x38b4b8b4,0x3b9c,0x0,0x80000000
.long 0x34f23b9c,0xbc00b8b4,0x80008000,0x0,0xbb9cbb9c,0xb8b4,0x0,0x80000000
.long 0x34f23c00,0xba79ba79,0xba7934f2,0x34f2ba79,0x34f23c00,0xba79ba79,0xba7934f2,0x34f2ba79
.long 0x34f23c00,0xba79ba79,0xba7934f2,0x34f2ba79,0x34f23c00,0xba79ba79,0xba7934f2,0x34f2ba79
.long 0xbb9c3c00,0xb8b43a79,0xb8b434f2,0xbb9c3a79,0xbb9c3c00,0xb8b43a79,0xb8b434f2,0xbb9c3a79
.long 0xbb9c3c00,0xb8b43a79,0xb8b434f2,0xbb9c3a79,0xbb9c3c00,0xb8b43a79,0xb8b434f2,0xbb9c3a79
.long 0xb4f23c00,0x3a79ba79,0x3a7934f2,0xb4f2ba79,0xb4f23c00,0x3a79ba79,0x3a7934f2,0xb4f2ba79
.long 0xb4f23c00,0x3a79ba79,0x3a7934f2,0xb4f2ba79,0xb4f23c00,0x3a79ba79,0x3a7934f2,0xb4f2ba79
.long 0x3b9c3c00,0x38b43a79,0x38b434f2,0x3b9c3a79,0x3b9c3c00,0x38b43a79,0x38b434f2,0x3b9c3a79
.long 0x3b9c3c00,0x38b43a79,0x38b434f2,0x3b9c3a79,0x3b9c3c00,0x38b43a79,0x38b434f2,0x3b9c3a79
.long 0x3c0034f2,0xba7934f2,0x0,0x80008000,0x3c0034f2,0xba7934f2,0x0,0x80008000
.long 0x3c0034f2,0xba7934f2,0x0,0x80008000,0x3c0034f2,0xba7934f2,0x0,0x80008000
.long 0x34f2,0x38b4b4f2,0x80000000,0x80000000,0x34f2,0x38b4b4f2,0x80000000,0x80000000
.long 0x34f2,0x38b4b4f2,0x80000000,0x80000000,0x34f2,0x38b4b4f2,0x80000000,0x80000000
.long 0xbc0034f2,0x3a7934f2,0x80000000,0x8000,0xbc0034f2,0x3a7934f2,0x80000000,0x8000
.long 0xbc0034f2,0x3a7934f2,0x80000000,0x8000,0xbc0034f2,0x3a7934f2,0x80000000,0x8000
.long 0x34f2,0xb8b4b4f2,0x0,0x0,0x34f2,0xb8b4b4f2,0x0,0x0
.long 0x34f2,0xb8b4b4f2,0x0,0x0,0x34f2,0xb8b4b4f2,0x0,0x0
.long 0x34f2ba79,0x34f23c00,0x0,0x80000000,0x34f2ba79,0x34f23c00,0x0,0x80000000
.long 0x34f2ba79,0x34f23c00,0x0,0x80000000,0x34f2ba79,0x34f23c00,0x0,0x80000000
.long 0x3b9cba79,0x3b9cbc00,0x0,0x8000,0x3b9cba79,0x3b9cbc00,0x0,0x8000
.long 0x3b9cba79,0x3b9cbc00,0x0,0x8000,0x3b9cba79,0x3b9cbc00,0x0,0x8000
.long 0xb4f2ba79,0xb4f23c00,0x80000000,0x0,0xb4f2ba79,0xb4f23c00,0x80000000,0x0
.long 0xb4f2ba79,0xb4f23c00,0x80000000,0x0,0xb4f2ba79,0xb4f23c00,0x80000000,0x0
.long 0xbb9cba79,0xbb9cbc00,0x0,0x80008000,0xbb9cba79,0xbb9cbc00,0x0,0x80008000
.long 0xbb9cba79,0xbb9cbc00,0x0,0x80008000,0xbb9cba79,0xbb9cbc00,0x0,0x80008000
.long 0xba79ba79,0x3c0034f2,0x8000,0x0,0xba79ba79,0x3c0034f2,0x8000,0x0
.long 0xba79ba79,0x3c0034f2,0x8000,0x0,0xba79ba79,0x3c0034f2,0x8000,0x0
.long 0x38b4ba79,0xb4f2,0x8000,0x8000,0x38b4ba79,0xb4f2,0x8000,0x8000
.long 0x38b4ba79,0xb4f2,0x8000,0x8000,0x38b4ba79,0xb4f2,0x8000,0x8000
.long 0x3a79ba79,0xbc0034f2,0x80008000,0x80000000,0x3a79ba79,0xbc0034f2,0x80008000,0x80000000
.long 0x3a79ba79,0xbc0034f2,0x80008000,0x80000000,0x3a79ba79,0xbc0034f2,0x80008000,0x80000000
.long 0xb8b4ba79,0xb4f2,0x80008000,0x80008000,0xb8b4ba79,0xb4f2,0x80008000,0x80008000
.long 0xb8b4ba79,0xb4f2,0x80008000,0x80008000,0xb8b4ba79,0xb4f2,0x80008000,0x80008000
.long 0x3b9c0000,0xb8b438b4,0x38b43b9c,0xbb9cb8b4,0x3b9c0000,0xb8b438b4,0x38b43b9c,0xbb9cb8b4
.long 0x3b9c0000,0xb8b438b4,0x38b43b9c,0xbb9cb8b4,0x3b9c0000,0xb8b438b4,0x38b43b9c,0xbb9cb8b4
.long 0x34f20000,0x3a79b8b4,0xba793b9c,0xb4f238b4,0x34f20000,0x3a79b8b4,0xba793b9c,0xb4f238b4
.long 0x34f20000,0x3a79b8b4,0xba793b9c,0xb4f238b4,0x34f20000,0x3a79b8b4,0xba793b9c,0xb4f238b4
.long 0xbb9c0000,0x38b438b4,0xb8b43b9c,0x3b9cb8b4,0xbb9c0000,0x38b438b4,0xb8b43b9c,0x3b9cb8b4
.long 0xbb9c0000,0x38b438b4,0xb8b43b9c,0x3b9cb8b4,0xbb9c0000,0x38b438b4,0xb8b43b9c,0x3b9cb8b4
.long 0xb4f20000,0xba79b8b4,0x3a793b9c,0x34f238b4,0xb4f20000,0xba79b8b4,0x3a793b9c,0x34f238b4
.long 0xb4f20000,0xba79b8b4,0x3a793b9c,0x34f238b4,0xb4f20000,0xba79b8b4,0x3a793b9c,0x34f238b4
.long 0xbb9c,0x38b43b9c,0x0,0x80000000,0xbb9c,0x38b43b9c,0x0,0x80000000
.long 0xbb9c,0x38b43b9c,0x0,0x80000000,0xbb9c,0x38b43b9c,0x0,0x80000000
.long 0x3c00bb9c,0x3a79bb9c,0x0,0x8000,0x3c00bb9c,0x3a79bb9c,0x0,0x8000
.long 0x3c00bb9c,0x3a79bb9c,0x0,0x8000,0x3c00bb9c,0x3a79bb9c,0x0,0x8000
.long 0xbb9c,0xb8b43b9c,0x80000000,0x0,0xbb9c,0xb8b43b9c,0x80000000,0x0
.long 0xbb9c,0xb8b43b9c,0x80000000,0x0,0xbb9c,0xb8b43b9c,0x80000000,0x0
.long 0xbc00bb9c,0xba79bb9c,0x80000000,0x80008000,0xbc00bb9c,0xba79bb9c,0x80000000,0x80008000
.long 0xbc00bb9c,0xba79bb9c,0x80000000,0x80008000,0xbc00bb9c,0xba79bb9c,0x80000000,0x80008000
.long 0xbb9cb8b4,0x3b9c0000,0x8000,0x0,0xbb9cb8b4,0x3b9c0000,0x8000,0x0
.long 0xbb9cb8b4,0x3b9c0000,0x8000,0x0,0xbb9cb8b4,0x3b9c0000,0x8000,0x0
.long 0x34f2b8b4,0xb4f20000,0x8000,0x8000,0x34f2b8b4,0xb4f20000,0x8000,0x8000
.long 0x34f2b8b4,0xb4f20000,0x8000,0x8000,0x34f2b8b4,0xb4f20000,0x8000,0x8000
.long 0x3b9cb8b4,0xbb9c0000,0x8000,0x80000000,0x3b9cb8b4,0xbb9c0000,0x8000,0x80000000
.long 0x3b9cb8b4,0xbb9c0000,0x8000,0x80000000,0x3b9cb8b4,0xbb9c0000,0x8000,0x80000000
.long 0xb4f2b8b4,0x34f20000,0x80008000,0x80008000,0xb4f2b8b4,0x34f20000,0x80008000,0x80008000
.long 0xb4f2b8b4,0x34f20000,0x80008000,0x80008000,0xb4f2b8b4,0x34f20000,0x80008000,0x80008000
.long 0xb8b438b4,0xbb9c,0x80008000,0x0,0xb8b438b4,0xbb9c,0x80008000,0x0
.long 0xb8b438b4,0xbb9c,0x80008000,0x0,0xb8b438b4,0xbb9c,0x80008000,0x0
.long 0xba7938b4,0xbc003b9c,0x8000,0x80000000,0xba7938b4,0xbc003b9c,0x8000,0x80000000
.long 0xba7938b4,0xbc003b9c,0x8000,0x80000000,0xba7938b4,0xbc003b9c,0x8000,0x80000000
.long 0x38b438b4,0xbb9c,0x8000,0x80000000,0x38b438b4,0xbb9c,0x8000,0x80000000
.long 0x38b438b4,0xbb9c,0x8000,0x80000000,0x38b438b4,0xbb9c,0x8000,0x80000000
.long 0x3a7938b4,0x3c003b9c,0x80008000,0x0,0x3a7938b4,0x3c003b9c,0x80008000,0x0
.long 0x3a7938b4,0x3c003b9c,0x80008000,0x0,0x3a7938b4,0x3c003b9c,0x80008000,0x0
.size ctab3, 10240
.globl k1_kernel
.p2align 8
.type k1_kernel,@function
k1_kernel:
    s_cmp_ge_u32 s2, 256
    s_nop 0
    s_cbranch_scc1 k1_kernel_end
    s_load_dwordx2 s[4:5], s[0:1], 0
    s_load_dwordx2 s[8:9], s[0:1], 8
    s_load_dwordx2 s[12:13], s[0:1], 16
    s_load_dwordx2 s[16:17], s[0:1], 72
    v_lshrrev_b32 v1, 6, v0
    s_nop 0
    v_readfirstlane_b32 s3, v1
    v_and_b32 v1, 63, v0
    v_and_b32 v2, 15, v0
    v_bfe_u32 v3, v0, 4, 2
    v_mul_u32_u24 v4, 320, v3
    v_lshl_add_u32 v4, v2, 2, v4
    s_lshr_b32 s22, s2, 5
    s_and_b32 s23, s2, 31
    s_lshl_b32 s20, s22, 3
    s_add_u32 s20, s20, s3
    s_lshl_b32 s20, s20, 5
    s_add_u32 s20, s20, s23
    s_mul_i32 s20, s20, 1280
    s_lshl_b32 s21, s23, 8
    s_lshl_b32 s22, s22, 5
    s_add_u32 s21, s21, s22
    s_mul_i32 s24, s3, 1280
    s_getpc_b64 s[54:55]
pc_cw_28:
    v_lshlrev_b32 v5, 3, v0
    s_sub_u32 s54, s54, pc_cw_28-k1_kernel
    s_subb_u32 s55, s55, 0
    v_min_u32 v5, k1_kernel_end-k1_kernel, v5
    global_load_dword v8, v5, s[54:55]
    s_bfe_u32 s56, s2, 0x20003
    s_lshl_b32 s56, s56, 14
    s_getpc_b64 s[54:55]
pc_cw_37:
    v_lshlrev_b32 v6, 5, v0
    v_add_u32 v6, s56, v6
    s_sub_u32 s54, s54, pc_cw_37-ctab3
    s_subb_u32 s55, s55, 0
    v_min_u32 v6, k3_kernel_end-ctab3, v6
    global_load_dword v9, v6, s[54:55]
    s_and_b32 s25, s3, 3
    s_lshr_b32 s26, s3, 2
    s_lshl_b32 s27, s26, 4
    v_add_u32 v14, s27, v2
    v_lshlrev_b32 v21, 4, v1
    s_lshl_b32 s27, s26, 11
    s_lshl_b32 s36, s25, 2
    s_add_u32 s36, s36, s27
    v_add_u32 v20, s36, v21
    v_mad_u32_u24 v15, v3, 5, s25
    v_mul_u32_u24 v13, v15, v14
    v_cvt_f32_u32 v17, v13
    v_mul_f32 v17, 0x3d4ccccd, v17
    v_cos_f32 v16, v17
    v_sin_f32 v17, v17
    v_mad_u32_u24 v15, v3, 5, 4
    v_mul_u32_u24 v13, v15, v14
    v_cvt_f32_u32 v19, v13
    v_mul_f32 v19, 0x3d4ccccd, v19
    v_cos_f32 v18, v19
    v_sin_f32 v19, v19
    v_mul_f32 v16, 0x3e800000, v16
    v_mul_f32 v17, 0x3e800000, v17
    v_cvt_pk_f16_f32 v13, v16, v17
    v_cvt_pk_f16_f32 v17, -v17, v16
    v_mov_b32 v16, v13
    v_mul_f32 v18, 0x3e800000, v18
    v_mul_f32 v19, 0x3e800000, v19
    v_cvt_pk_f16_f32 v13, v18, v19
    v_cvt_pk_f16_f32 v19, -v19, v18
    v_mov_b32 v18, v13
    ds_write_b32 v20, v16 offset:10496
    ds_write_b32 v20, v17 offset:11520
    s_lshl_b32 s27, s26, 3
    v_add_u32 v13, s27, v21
    ds_write_b64 v13, v[18:19] offset:20736
    v_mad_u32_u24 v15, v3, 4, s25
    v_mul_u32_u24 v13, v15, v14
    v_cvt_f32_u32 v17, v13
    v_mul_f32 v17, 0x3b4ccccd, v17
    v_cos_f32 v16, v17
    v_sin_f32 v17, v17
    v_mul_u32_u24 v13, v15, v2
    v_and_b32 v13, 15, v13
    v_cvt_f32_u32 v19, v13
    v_mul_f32 v19, 0x3d800000, v19
    v_cos_f32 v18, v19
    v_sin_f32 v19, v19
    ds_write_b32 v20, v16 offset:14592
    ds_write_b32 v20, v17 offset:15616
    v_mul_f32 v18, 0x3e800000, v18
    v_mul_f32 v19, 0x3e800000, v19
    v_and_b32 v20, 0x7ff, v20
    ds_write_b32 v20, v18 offset:18688
    ds_write_b32 v20, v19 offset:19712
    s_waitcnt lgkmcnt(0)
    s_add_u32 s28, s16, 0x500000
    s_addc_u32 s29, s17, 0
    s_mov_b32 s30, 0x288000
    s_mov_b32 s31, 0x00020000
    s_add_u32 s32, s16, 0x7a0000
    s_addc_u32 s33, s17, 0
    s_mov_b32 s34, 0x400
    s_mov_b32 s35, 0x00020000
    s_mov_b32 s6, 0x280000
    s_mov_b32 s7, 0x00020000
    s_mov_b32 s10, 0x141000
    s_mov_b32 s11, 0x00020000
    s_mov_b32 s14, 0x141000
    s_mov_b32 s15, 0x00020000
    s_mov_b32 s18, 0x280000
    s_mov_b32 s19, 0x00020000
    buffer_load_dword v8, v4, s[4:7], s20 offen offset:0
    buffer_load_dword v9, v4, s[4:7], s20 offen offset:64
    buffer_load_dword v10, v4, s[4:7], s20 offen offset:128
    buffer_load_dword v11, v4, s[4:7], s20 offen offset:192
    buffer_load_dword v12, v4, s[4:7], s20 offen offset:256
    v_mov_b32 v96, 0
    s_mov_b32 s48, 0
    s_and_b32 s25, s3, 3
    s_cmp_eq_u32 s25, 3
    s_nop 1
    s_cbranch_scc1 k1_now1
    v_and_b32 v97, 255, v0
    v_min_u32 v97, 161, v97
    s_and_b32 s26, s2, 63
    s_lshr_b32 s27, s2, 6
    s_lshl_b32 s36, s27, 8
    s_add_u32 s36, s36, s26
    s_cmp_ge_u32 s3, 4
    s_cselect_b32 s37, 1, 0
    s_add_u32 s38, s36, 0
    s_sub_u32 s39, 2048, s38
    s_and_b32 s39, s39, 2047
    s_cmp_eq_u32 s37, 1
    s_cselect_b32 s38, s39, s38
    s_mul_i32 s40, s38, 642
    s_add_u32 s38, s36, 64
    s_sub_u32 s39, 2048, s38
    s_and_b32 s39, s39, 2047
    s_cmp_eq_u32 s37, 1
    s_cselect_b32 s38, s39, s38
    s_mul_i32 s41, s38, 642
    s_add_u32 s38, s36, 128
    s_sub_u32 s39, 2048, s38
    s_and_b32 s39, s39, 2047
    s_cmp_eq_u32 s37, 1
    s_cselect_b32 s38, s39, s38
    s_mul_i32 s42, s38, 642
    s_add_u32 s38, s36, 192
    s_sub_u32 s39, 2048, s38
    s_and_b32 s39, s39, 2047
    s_cmp_eq_u32 s37, 1
    s_cselect_b32 s38, s39, s38
    s_mul_i32 s43, s38, 642
    s_add_u32 s38, s36, 1024
    s_sub_u32 s39, 2048, s38
    s_and_b32 s39, s39, 2047
    s_cmp_eq_u32 s37, 1
    s_cselect_b32 s38, s39, s38
    s_mul_i32 s44, s38, 642
    s_add_u32 s38, s36, 1088
    s_sub_u32 s39, 2048, s38
    s_and_b32 s39, s39, 2047
    s_cmp_eq_u32 s37, 1
    s_cselect_b32 s38, s39, s38
    s_mul_i32 s45, s38, 642
    s_add_u32 s38, s36, 1152
    s_sub_u32 s39, 2048, s38
    s_and_b32 s39, s39, 2047
    s_cmp_eq_u32 s37, 1
    s_cselect_b32 s38, s39, s38
    s_mul_i32 s46, s38, 642
    s_add_u32 s38, s36, 1216
    s_sub_u32 s39, 2048, s38
    s_and_b32 s39, s39, 2047
    s_cmp_eq_u32 s37, 1
    s_cselect_b32 s38, s39, s38
    s_mul_i32 s47, s38, 642
    s_lshr_b32 s38, s26, 4
    s_lshl_b32 s38, s38, 6
    s_lshl_b32 s39, s27, 4
    s_add_u32 s38, s38, s39
    s_and_b32 s39, s26, 15
    s_add_u32 s38, s38, s39
    s_lshl_b32 s48, s38, 5
    s_cmp_eq_u32 s37, 1
    s_cselect_b32 s38, 320, 0
    s_cselect_b32 s39, -1, 1
    s_cselect_b32 s49, 0, 320
    s_cselect_b32 s50, 162, 0
    s_sub_u32 s51, 323, s50
    v_mul_lo_u32 v98, v97, s39
    v_add_u32 v98, s38, v98
    v_add_u32 v96, s50, v97
    v_cmp_eq_u32 vcc, 161, v97
    v_mov_b32 v97, s49
    s_nop 0
    v_cndmask_b32 v98, v98, v97, vcc
    v_mov_b32 v97, s51
    v_cndmask_b32 v96, v96, v97, vcc
    v_lshlrev_b32 v98, 1, v98
    v_lshlrev_b32 v96, 13, v96
    buffer_load_ushort v80, v98, s[8:11], s40 offen
    buffer_load_ushort v88, v98, s[12:15], s40 offen
    buffer_load_ushort v81, v98, s[8:11], s41 offen
    buffer_load_ushort v89, v98, s[12:15], s41 offen
    buffer_load_ushort v82, v98, s[8:11], s42 offen
    buffer_load_ushort v90, v98, s[12:15], s42 offen
    buffer_load_ushort v83, v98, s[8:11], s43 offen
    buffer_load_ushort v91, v98, s[12:15], s43 offen
    buffer_load_ushort v84, v98, s[8:11], s44 offen
    buffer_load_ushort v92, v98, s[12:15], s44 offen
    buffer_load_ushort v85, v98, s[8:11], s45 offen
    buffer_load_ushort v93, v98, s[12:15], s45 offen
    buffer_load_ushort v86, v98, s[8:11], s46 offen
    buffer_load_ushort v94, v98, s[12:15], s46 offen
    buffer_load_ushort v87, v98, s[8:11], s47 offen
    buffer_load_ushort v95, v98, s[12:15], s47 offen
k1_now1:
    v_mov_b32 v73, 0
    v_mov_b32 v74, 0
    v_mov_b32 v75, 0
    s_barrier
    ds_read_b128 v[104:107], v21 offset:18688
    ds_read_b128 v[108:111], v21 offset:19712
    ds_read_b128 v[100:103], v21 offset:20736
    ds_read_b128 v[24:27], v21 offset:10496
    ds_read_b128 v[28:31], v21 offset:11520
    ds_read_b128 v[56:59], v21 offset:14592
    ds_read_b128 v[64:67], v21 offset:15616
    ds_read_b128 v[32:35], v21 offset:12544
    ds_read_b128 v[36:39], v21 offset:13568
    ds_read_b128 v[60:63], v21 offset:16640
    ds_read_b128 v[68:71], v21 offset:17664
    v_mov_b32 v41, 0
    v_mov_b32 v43, 0
    v_mov_b32 v45, 0
    v_mov_b32 v47, 0
    s_waitcnt lgkmcnt(8)
    v_cvt_pk_f16_f32 v48, v104, v105
    v_cvt_pk_f16_f32 v50, v108, v109
    v_cvt_pk_f16_f32 v52, -v108, -v109
    v_mov_b32 v54, v48
    v_cvt_pk_f16_f32 v49, v106, v107
    v_cvt_pk_f16_f32 v51, v110, v111
    v_cvt_pk_f16_f32 v53, -v110, -v111
    v_mov_b32 v55, v49
    v_mov_b32 v40, v100
    v_mov_b32 v42, v101
    v_mov_b32 v44, v102
    v_mov_b32 v46, v103
    s_waitcnt lgkmcnt(0)
    s_cmp_eq_u32 s25, 3
    s_nop 2
    s_cbranch_scc1 k1_w0
    s_waitcnt vmcnt(16)
    s_nop 0
    s_branch k1_w1
    s_nop 0
k1_w0:
    s_waitcnt vmcnt(0)
    s_nop 0
k1_w1:
    v_lshlrev_b32 v112, 16, v8
    v_and_b32 v113, 0xffff0000, v8
    v_lshlrev_b32 v114, 16, v9
    v_and_b32 v115, 0xffff0000, v9
    v_lshlrev_b32 v116, 16, v10
    v_and_b32 v117, 0xffff0000, v10
    v_lshlrev_b32 v118, 16, v11
    v_and_b32 v119, 0xffff0000, v11
    v_lshlrev_b32 v120, 16, v12
    v_and_b32 v121, 0xffff0000, v12
    v_add_f32 v129, v112, v113
    v_add_f32 v129, v129, v114
    v_add_f32 v129, v129, v115
    v_add_f32 v129, v129, v116
    v_add_f32 v129, v129, v117
    v_add_f32 v129, v129, v118
    v_add_f32 v129, v129, v119
    v_add_f32 v129, v129, v120
    v_add_f32 v129, v129, v121
    s_nop 1
    v_add_f32_dpp v129, v129, v129 quad_perm:[1,0,3,2] row_mask:0xf bank_mask:0xf
    s_nop 1
    v_add_f32_dpp v129, v129, v129 quad_perm:[2,3,0,1] row_mask:0xf bank_mask:0xf
    s_nop 1
    v_add_f32_dpp v129, v129, v129 row_half_mirror row_mask:0xf bank_mask:0xf
    s_nop 1
    v_add_f32_dpp v129, v129, v129 row_mirror row_mask:0xf bank_mask:0xf
    v_mov_b32 v130, v129
    s_nop 1
    v_permlane16_swap_b32 v129, v130
    v_add_f32 v129, v129, v130
    v_mov_b32 v130, v129
    s_nop 1
    v_permlane32_swap_b32 v129, v130
    v_add_f32 v129, v129, v130
    v_mul_f32 v131, 0x3acccccd, v129
    v_sub_f32 v130, v112, v131
    v_mul_f32 v129, v130, v130
    v_sub_f32 v130, v113, v131
    v_fmac_f32 v129, v130, v130
    v_sub_f32 v130, v114, v131
    v_fmac_f32 v129, v130, v130
    v_sub_f32 v130, v115, v131
    v_fmac_f32 v129, v130, v130
    v_sub_f32 v130, v116, v131
    v_fmac_f32 v129, v130, v130
    v_sub_f32 v130, v117, v131
    v_fmac_f32 v129, v130, v130
    v_sub_f32 v130, v118, v131
    v_fmac_f32 v129, v130, v130
    v_sub_f32 v130, v119, v131
    v_fmac_f32 v129, v130, v130
    v_sub_f32 v130, v120, v131
    v_fmac_f32 v129, v130, v130
    v_sub_f32 v130, v121, v131
    v_fmac_f32 v129, v130, v130
    s_nop 1
    v_add_f32_dpp v129, v129, v129 quad_perm:[1,0,3,2] row_mask:0xf bank_mask:0xf
    s_nop 1
    v_add_f32_dpp v129, v129, v129 quad_perm:[2,3,0,1] row_mask:0xf bank_mask:0xf
    s_nop 1
    v_add_f32_dpp v129, v129, v129 row_half_mirror row_mask:0xf bank_mask:0xf
    s_nop 1
    v_add_f32_dpp v129, v129, v129 row_mirror row_mask:0xf bank_mask:0xf
    v_mov_b32 v130, v129
    s_nop 1
    v_permlane16_swap_b32 v129, v130
    v_add_f32 v129, v129, v130
    v_mov_b32 v130, v129
    s_nop 1
    v_permlane32_swap_b32 v129, v130
    v_add_f32 v129, v129, v130
    v_mul_f32 v129, 0x3acccccd, v129
    v_cvt_pk_bf16_f32 v129, v129, v129
    v_lshlrev_b32 v129, 16, v129
    v_cvt_pk_bf16_f32 v131, v131, v131
    v_lshlrev_b32 v131, 16, v131
    v_add_f32 v129, 0x3727c5ac, v129
    v_cvt_pk_bf16_f32 v129, v129, v129
    v_lshlrev_b32 v129, 16, v129
    v_sqrt_f32 v129, v129
    s_nop 0
    v_cvt_pk_bf16_f32 v129, v129, v129
    v_lshlrev_b32 v129, 16, v129
    v_rcp_f32 v130, v129
    v_sub_f32 v112, v112, v131
    v_sub_f32 v113, v113, v131
    v_cvt_pk_bf16_f32 v113, v112, v113
    v_lshlrev_b32 v112, 16, v113
    v_and_b32 v113, 0xffff0000, v113
    v_mul_f32 v132, v112, v130
    v_mul_f32 v134, v113, v130
    v_fma_f32 v133, -v132, v129, v112
    v_fma_f32 v135, -v134, v129, v113
    v_fmac_f32 v132, v133, v130
    v_fmac_f32 v134, v135, v130
    v_cvt_pk_bf16_f32 v124, v132, v134
    v_sub_f32 v114, v114, v131
    v_sub_f32 v115, v115, v131
    v_cvt_pk_bf16_f32 v115, v114, v115
    v_lshlrev_b32 v114, 16, v115
    v_and_b32 v115, 0xffff0000, v115
    v_mul_f32 v132, v114, v130
    v_mul_f32 v134, v115, v130
    v_fma_f32 v133, -v132, v129, v114
    v_fma_f32 v135, -v134, v129, v115
    v_fmac_f32 v132, v133, v130
    v_fmac_f32 v134, v135, v130
    v_cvt_pk_bf16_f32 v125, v132, v134
    v_sub_f32 v116, v116, v131
    v_sub_f32 v117, v117, v131
    v_cvt_pk_bf16_f32 v117, v116, v117
    v_lshlrev_b32 v116, 16, v117
    v_and_b32 v117, 0xffff0000, v117
    v_mul_f32 v132, v116, v130
    v_mul_f32 v134, v117, v130
    v_fma_f32 v133, -v132, v129, v116
    v_fma_f32 v135, -v134, v129, v117
    v_fmac_f32 v132, v133, v130
    v_fmac_f32 v134, v135, v130
    v_cvt_pk_bf16_f32 v126, v132, v134
    v_sub_f32 v118, v118, v131
    v_sub_f32 v119, v119, v131
    v_cvt_pk_bf16_f32 v119, v118, v119
    v_lshlrev_b32 v118, 16, v119
    v_and_b32 v119, 0xffff0000, v119
    v_mul_f32 v132, v118, v130
    v_mul_f32 v134, v119, v130
    v_fma_f32 v133, -v132, v129, v118
    v_fma_f32 v135, -v134, v129, v119
    v_fmac_f32 v132, v133, v130
    v_fmac_f32 v134, v135, v130
    v_cvt_pk_bf16_f32 v127, v132, v134
    v_sub_f32 v120, v120, v131
    v_sub_f32 v121, v121, v131
    v_cvt_pk_bf16_f32 v121, v120, v121
    v_lshlrev_b32 v120, 16, v121
    v_and_b32 v121, 0xffff0000, v121
    v_mul_f32 v132, v120, v130
    v_mul_f32 v134, v121, v130
    v_fma_f32 v133, -v132, v129, v120
    v_fma_f32 v135, -v134, v129, v121
    v_fmac_f32 v132, v133, v130
    v_fmac_f32 v134, v135, v130
    v_cvt_pk_bf16_f32 v128, v132, v134
    v_lshlrev_b32 v16, 16, v124
    v_and_b32 v17, 0xffff0000, v124
    v_cvt_pk_f16_f32 v76, v16, v17
    v_lshlrev_b32 v16, 16, v125
    v_and_b32 v17, 0xffff0000, v125
    v_cvt_pk_f16_f32 v77, v16, v17
    v_lshlrev_b32 v16, 16, v126
    v_and_b32 v17, 0xffff0000, v126
    v_cvt_pk_f16_f32 v78, v16, v17
    v_lshlrev_b32 v16, 16, v127
    v_and_b32 v17, 0xffff0000, v127
    v_cvt_pk_f16_f32 v79, v16, v17
    v_lshlrev_b32 v16, 16, v128
    v_and_b32 v17, 0xffff0000, v128
    v_cvt_pk_f16_f32 v72, v16, v17
    s_cmp_eq_u32 s25, 3
    s_nop 3
    s_cbranch_scc1 k1_w2
    s_waitcnt vmcnt(16)
    s_nop 0
    s_branch k1_w3
    s_nop 0
k1_w2:
    s_waitcnt vmcnt(0)
    s_nop 0
k1_w3:
    v_mfma_f32_16x16x32_f16 v[132:135], v[76:79], v[24:27], 0
    v_mfma_f32_16x16x32_f16 v[136:139], v[76:79], v[28:31], 0
    v_mfma_f32_16x16x32_f16 v[140:143], v[76:79], v[32:35], 0
    v_mfma_f32_16x16x32_f16 v[144:147], v[76:79], v[36:39], 0
    v_mfma_f32_16x16x32_f16 v[132:135], v[72:75], v[40:43], v[132:135]
    v_mfma_f32_16x16x32_f16 v[136:139], v[72:75], v[42:45], v[136:139]
    v_mfma_f32_16x16x32_f16 v[140:143], v[72:75], v[44:47], v[140:143]
    v_mfma_f32_16x16x32_f16 v[144:147], v[72:75], v[46:49], v[144:147]
    s_nop 4
    v_mul_f32 v156, v132, v56
    v_mul_f32 v160, v136, v56
    v_fmac_f32 v156, v136, v64
    v_fma_f32 v160, -v132, v64, v160
    v_mul_f32 v157, v133, v57
    v_mul_f32 v161, v137, v57
    v_fmac_f32 v157, v137, v65
    v_fma_f32 v161, -v133, v65, v161
    v_mul_f32 v158, v134, v58
    v_mul_f32 v162, v138, v58
    v_fmac_f32 v158, v138, v66
    v_fma_f32 v162, -v134, v66, v162
    v_mul_f32 v159, v135, v59
    v_mul_f32 v163, v139, v59
    v_fmac_f32 v159, v139, v67
    v_fma_f32 v163, -v135, v67, v163
    v_cvt_pk_f16_f32 v148, v156, v157
    v_cvt_pk_f16_f32 v149, v158, v159
    v_cvt_pk_f16_f32 v150, v160, v161
    v_cvt_pk_f16_f32 v151, v162, v163
    v_mul_f32 v156, v140, v60
    v_mul_f32 v160, v144, v60
    v_fmac_f32 v156, v144, v68
    v_fma_f32 v160, -v140, v68, v160
    v_mul_f32 v157, v141, v61
    v_mul_f32 v161, v145, v61
    v_fmac_f32 v157, v145, v69
    v_fma_f32 v161, -v141, v69, v161
    v_mul_f32 v158, v142, v62
    v_mul_f32 v162, v146, v62
    v_fmac_f32 v158, v146, v70
    v_fma_f32 v162, -v142, v70, v162
    v_mul_f32 v159, v143, v63
    v_mul_f32 v163, v147, v63
    v_fmac_f32 v159, v147, v71
    v_fma_f32 v163, -v143, v71, v163
    v_cvt_pk_f16_f32 v152, v156, v157
    v_cvt_pk_f16_f32 v153, v158, v159
    v_cvt_pk_f16_f32 v154, v160, v161
    v_cvt_pk_f16_f32 v155, v162, v163
    v_mfma_f32_16x16x32_f16 v[132:135], v[48:51], v[148:151], 0
    v_mfma_f32_16x16x32_f16 v[136:139], v[52:55], v[148:151], 0
    v_mfma_f32_16x16x32_f16 v[140:143], v[48:51], v[152:155], 0
    v_mfma_f32_16x16x32_f16 v[144:147], v[52:55], v[152:155], 0
    v_add_u32 v164, s24, v4
    s_nop 4
    v_cvt_pk_f16_f32 v132, v132, v136
    v_cvt_pk_f16_f32 v133, v133, v137
    v_cvt_pk_f16_f32 v134, v134, v138
    v_cvt_pk_f16_f32 v135, v135, v139
    v_cvt_pk_f16_f32 v140, v140, v144
    v_cvt_pk_f16_f32 v141, v141, v145
    v_cvt_pk_f16_f32 v142, v142, v146
    v_cvt_pk_f16_f32 v143, v143, v147
    ds_write_b32 v164, v132 offset:0
    ds_write_b32 v164, v133 offset:80
    ds_write_b32 v164, v134 offset:160
    ds_write_b32 v164, v135 offset:240
    s_mov_b32 s52, 0x000f000f
    s_mov_b32 exec_lo, s52
    s_mov_b32 exec_hi, s52
    ds_write_b32 v164, v140 offset:64
    ds_write_b32 v164, v141 offset:144
    ds_write_b32 v164, v142 offset:224
    ds_write_b32 v164, v143 offset:304
    s_mov_b64 exec, -1
    v_mov_b32 v165, 0
    s_cmp_eq_u32 s25, 3
    s_nop 3
    s_cbranch_scc1 k1_now2
    s_waitcnt vmcnt(0)
    v_lshl_or_b32 v80, v88, 16, v80
    v_lshl_or_b32 v81, v89, 16, v81
    v_lshl_or_b32 v82, v90, 16, v82
    v_lshl_or_b32 v83, v91, 16, v83
    v_lshl_or_b32 v84, v92, 16, v84
    v_lshl_or_b32 v85, v93, 16, v85
    v_lshl_or_b32 v86, v94, 16, v86
    v_lshl_or_b32 v87, v95, 16, v87
    buffer_store_dwordx4 v[80:83], v96, s[28:31], s48 offen
    buffer_store_dwordx4 v[84:87], v96, s[28:31], s48 offen offset:16
    v_and_b32 v166, 0x7fff7fff, v80
    v_pk_max_u16 v165, v165, v166
    v_and_b32 v166, 0x7fff7fff, v81
    v_pk_max_u16 v165, v165, v166
    v_and_b32 v166, 0x7fff7fff, v82
    v_pk_max_u16 v165, v165, v166
    v_and_b32 v166, 0x7fff7fff, v83
    v_pk_max_u16 v165, v165, v166
    v_and_b32 v166, 0x7fff7fff, v84
    v_pk_max_u16 v165, v165, v166
    v_and_b32 v166, 0x7fff7fff, v85
    v_pk_max_u16 v165, v165, v166
    v_and_b32 v166, 0x7fff7fff, v86
    v_pk_max_u16 v165, v165, v166
    v_and_b32 v166, 0x7fff7fff, v87
    v_pk_max_u16 v165, v165, v166
    v_lshrrev_b32 v166, 16, v165
    v_and_b32 v165, 0xffff, v165
    v_max_u32 v165, v165, v166
    s_nop 1
    v_max_u32_dpp v165, v165, v165 quad_perm:[1,0,3,2] row_mask:0xf bank_mask:0xf
    s_nop 1
    v_max_u32_dpp v165, v165, v165 quad_perm:[2,3,0,1] row_mask:0xf bank_mask:0xf
    s_nop 1
    v_max_u32_dpp v165, v165, v165 row_half_mirror row_mask:0xf bank_mask:0xf
    s_nop 1
    v_max_u32_dpp v165, v165, v165 row_mirror row_mask:0xf bank_mask:0xf
    v_mov_b32 v166, v165
    s_nop 1
    v_permlane16_swap_b32 v165, v166
    v_max_u32 v165, v165, v166
    v_mov_b32 v166, v165
    s_nop 1
    v_permlane32_swap_b32 v165, v166
    v_max_u32 v165, v165, v166
    s_nop 4
k1_now2:
    s_lshl_b32 s26, s3, 2
    s_add_u32 s26, s26, 10240
    v_mov_b32 v166, s26
    ds_write_b32 v166, v165
    s_waitcnt lgkmcnt(0)
    s_barrier
    s_cmp_ge_u32 s3, 5
    s_nop 0
    s_cbranch_scc1 k1_nost
    v_lshlrev_b32 v164, 2, v0
    ds_read2st64_b32 v[168:169], v164 offset0:0 offset1:5
    ds_read2st64_b32 v[170:171], v164 offset0:10 offset1:15
    ds_read2st64_b32 v[172:173], v164 offset0:20 offset1:25
    ds_read2st64_b32 v[174:175], v164 offset0:30 offset1:35
    v_lshlrev_b32 v166, 13, v0
    s_waitcnt lgkmcnt(0)
    buffer_store_dwordx4 v[168:171], v166, s[16:19], s21 offen
    buffer_store_dwordx4 v[172:175], v166, s[16:19], s21 offen offset:16
    s_endpgm
    s_nop 0
k1_nost:
    s_cmp_lg_u32 s3, 7
    s_nop 0
    s_cbranch_scc1 k1_kernel_end
    v_mov_b32 v164, 10240
    ds_read_b128 v[168:171], v164
    ds_read_b128 v[172:175], v164 offset:16
    s_lshl_b32 s26, s2, 2
    v_mov_b32 v166, 0
    s_waitcnt lgkmcnt(0)
    v_max3_u32 v165, v168, v169, v170
    v_max3_u32 v165, v165, v171, v172
    v_max3_u32 v165, v165, v173, v174
    v_max_u32 v165, v165, v175
    s_mov_b64 exec, 1
    buffer_store_dword v165, v166, s[32:35], s26 offen
    s_nop 2
k1_kernel_end:
    s_endpgm
.globl k2_kernel
.p2align 8
.type k2_kernel,@function
k2_kernel:
    s_cmp_ge_u32 s2, 273
    s_nop 0
    s_cbranch_scc1 k2_kernel_end
    s_load_dwordx2 s[16:17], s[0:1], 72
    s_cmp_ge_u32 s2, 161
    s_nop 0
    s_cbranch_scc1 k2_pack
    s_getpc_b64 s[4:5]
pc_cw_615:
    v_lshlrev_b32 v254, 6, v0
    s_sub_u32 s4, s4, pc_cw_615-k2_kernel
    s_subb_u32 s5, s5, 0
    v_min_u32 v254, k2_pack-k2_kernel, v254
    global_load_dword v255, v254, s[4:5]
    v_lshrrev_b32 v1, 6, v0
    s_nop 0
    v_readfirstlane_b32 s3, v1
    v_and_b32 v1, 63, v0
    v_and_b32 v2, 15, v0
    v_bfe_u32 v3, v0, 4, 2
    v_lshlrev_b32 v4, 2, v3
    s_lshl_b32 s4, s3, 4
    v_add_u32 v5, s4, v2
    v_lshlrev_b32 v6, 8, v2
    v_lshl_add_u32 v6, v3, 4, v6
    s_sub_u32 s5, 320, s2
    s_cmp_eq_u32 s2, 0
    s_cselect_b32 s5, 0, s5
    s_lshl_b32 s6, s2, 13
    s_lshl_b32 s7, s5, 13
    s_add_u32 s8, s6, 4096
    s_add_u32 s9, s7, 4096
    s_add_u32 s10, s6, 1327104
    v_cvt_f32_u32 v75, v1
    v_mul_f32 v75, 0x3c800000, v75
    v_cos_f32 v74, v75
    v_sin_f32 v75, v75
    v_mul_f32 v74, 0x3e000000, v74
    v_mul_f32 v75, 0x3e000000, v75
    v_cvt_pk_f16_f32 v64, v74, v75
    v_pk_add_f16 v65, v64, v64
    s_lshl_b32 s24, s3, 3
    s_add_u32 s24, s24, 0
    v_add_u32 v72, s24, v3
    v_xor_b32 v73, v72, v2
    v_and_b32 v73, 15, v73
    v_lshlrev_b32 v72, 8, v72
    v_lshl_add_u32 v66, v73, 4, v72
    s_lshl_b32 s24, s3, 3
    s_add_u32 s24, s24, 4
    v_add_u32 v72, s24, v3
    v_xor_b32 v73, v72, v2
    v_and_b32 v73, 15, v73
    v_lshlrev_b32 v72, 8, v72
    v_lshl_add_u32 v67, v73, 4, v72
    v_add_u32 v73, 0, v3
    v_xor_b32 v73, v73, v2
    v_lshlrev_b32 v73, 4, v73
    v_lshl_add_u32 v68, v2, 8, v73
    v_add_u32 v73, 4, v3
    v_xor_b32 v73, v73, v2
    v_lshlrev_b32 v73, 4, v73
    v_lshl_add_u32 v69, v2, 8, v73
    v_add_u32 v73, 8, v3
    v_xor_b32 v73, v73, v2
    v_lshlrev_b32 v73, 4, v73
    v_lshl_add_u32 v70, v2, 8, v73
    v_add_u32 v73, 12, v3
    v_xor_b32 v73, v73, v2
    v_lshlrev_b32 v73, 4, v73
    v_lshl_add_u32 v71, v2, 8, v73
    s_lshl_b32 s25, s3, 11
    s_waitcnt lgkmcnt(0)
    s_add_u32 s20, s16, 0x280000
    s_addc_u32 s21, s17, 0
    s_mov_b32 s22, 0x280000
    s_mov_b32 s23, 0x00020000
    s_add_u32 s28, s16, 0x500000
    s_addc_u32 s29, s17, 0
    s_mov_b32 s30, 0x288000
    s_mov_b32 s31, 0x00020000
    s_add_u32 s32, s16, 0x7a0000
    s_addc_u32 s33, s17, 0
    s_mov_b32 s34, 0x400
    s_mov_b32 s35, 0x00020000
    s_mov_b32 s18, 0x280000
    s_mov_b32 s19, 0x00020000
    s_add_u32 m0, s25, 16384
    s_nop 0
    buffer_load_dwordx4 v66, s[16:19], s6 offen lds
    s_add_u32 m0, s25, 17408
    s_nop 0
    buffer_load_dwordx4 v67, s[16:19], s6 offen lds
    s_add_u32 m0, s25, 24576
    s_nop 0
    buffer_load_dwordx4 v66, s[16:19], s7 offen lds
    s_add_u32 m0, s25, 25600
    s_nop 0
    buffer_load_dwordx4 v67, s[16:19], s7 offen lds
    v_lshlrev_b32 v152, 4, v1
    buffer_load_dwordx4 v[148:151], v152, s[32:35], 0 offen
    v_lshlrev_b32 v188, 5, v0
    buffer_load_dwordx4 v[156:159], v188, s[28:31], s6 offen
    buffer_load_dwordx4 v[160:163], v188, s[28:31], s6 offen offset:16
    buffer_load_dwordx4 v[164:167], v188, s[28:31], s10 offen
    buffer_load_dwordx4 v[168:171], v188, s[28:31], s10 offen offset:16
    v_lshlrev_b32 v78, 2, v5
    v_mul_u32_u24 v73, v4, v78
    ds_bpermute_b32 v8, v73, v64
    v_add_u32 v73, v73, v78
    ds_bpermute_b32 v9, v73, v64
    v_add_u32 v73, v73, v78
    ds_bpermute_b32 v10, v73, v64
    v_add_u32 v73, v73, v78
    ds_bpermute_b32 v11, v73, v64
    v_add_u32 v73, v73, v78
    v_mad_u32_u24 v73, 12, v78, v73
    ds_bpermute_b32 v12, v73, v64
    v_add_u32 v73, v73, v78
    ds_bpermute_b32 v13, v73, v64
    v_add_u32 v73, v73, v78
    ds_bpermute_b32 v14, v73, v64
    v_add_u32 v73, v73, v78
    ds_bpermute_b32 v15, v73, v64
    v_add_u32 v73, v73, v78
    v_mad_u32_u24 v73, 12, v78, v73
    s_waitcnt lgkmcnt(0)
    ds_bpermute_b32 v16, v73, v64
    v_add_u32 v73, v73, v78
    ds_bpermute_b32 v17, v73, v64
    v_add_u32 v73, v73, v78
    ds_bpermute_b32 v18, v73, v64
    v_add_u32 v73, v73, v78
    ds_bpermute_b32 v19, v73, v64
    v_add_u32 v73, v73, v78
    v_mad_u32_u24 v73, 12, v78, v73
    ds_bpermute_b32 v20, v73, v64
    v_add_u32 v73, v73, v78
    ds_bpermute_b32 v21, v73, v64
    v_add_u32 v73, v73, v78
    ds_bpermute_b32 v22, v73, v64
    v_add_u32 v73, v73, v78
    ds_bpermute_b32 v23, v73, v64
    v_add_u32 v73, v73, v78
    s_waitcnt lgkmcnt(0)
    v_add_u32 v78, 0, v2
    v_lshlrev_b32 v78, 3, v78
    v_mul_u32_u24 v73, v4, v78
    ds_bpermute_b32 v24, v73, v65
    v_add_u32 v73, v73, v78
    ds_bpermute_b32 v25, v73, v65
    v_add_u32 v73, v73, v78
    ds_bpermute_b32 v26, v73, v65
    v_add_u32 v73, v73, v78
    ds_bpermute_b32 v27, v73, v65
    v_add_u32 v73, v73, v78
    v_mad_u32_u24 v73, 12, v78, v73
    ds_bpermute_b32 v28, v73, v65
    v_add_u32 v73, v73, v78
    ds_bpermute_b32 v29, v73, v65
    v_add_u32 v73, v73, v78
    ds_bpermute_b32 v30, v73, v65
    v_add_u32 v73, v73, v78
    ds_bpermute_b32 v31, v73, v65
    v_add_u32 v73, v73, v78
    s_waitcnt lgkmcnt(0)
    v_add_u32 v78, 16, v2
    v_lshlrev_b32 v78, 3, v78
    v_mul_u32_u24 v73, v4, v78
    ds_bpermute_b32 v32, v73, v65
    v_add_u32 v73, v73, v78
    ds_bpermute_b32 v33, v73, v65
    v_add_u32 v73, v73, v78
    ds_bpermute_b32 v34, v73, v65
    v_add_u32 v73, v73, v78
    ds_bpermute_b32 v35, v73, v65
    v_add_u32 v73, v73, v78
    v_mad_u32_u24 v73, 12, v78, v73
    ds_bpermute_b32 v36, v73, v65
    v_add_u32 v73, v73, v78
    ds_bpermute_b32 v37, v73, v65
    v_add_u32 v73, v73, v78
    ds_bpermute_b32 v38, v73, v65
    v_add_u32 v73, v73, v78
    ds_bpermute_b32 v39, v73, v65
    v_add_u32 v73, v73, v78
    s_mov_b32 s13, 0x05040100
    s_mov_b32 s14, 0x07060302
    v_mul_u32_u24 v72, v4, v5
    v_cvt_f32_u32 v200, v72
    v_mul_f32 v200, 0x3a000000, v200
    v_cos_f32 v192, v200
    v_sin_f32 v200, v200
    v_add_u32 v72, v72, v5
    v_cvt_f32_u32 v201, v72
    v_mul_f32 v201, 0x3a000000, v201
    v_cos_f32 v193, v201
    v_sin_f32 v201, v201
    v_add_u32 v72, v72, v5
    v_cvt_f32_u32 v202, v72
    v_mul_f32 v202, 0x3a000000, v202
    v_cos_f32 v194, v202
    v_sin_f32 v202, v202
    v_add_u32 v72, v72, v5
    v_cvt_f32_u32 v203, v72
    v_mul_f32 v203, 0x3a000000, v203
    v_cos_f32 v195, v203
    v_sin_f32 v203, v203
    v_add_u32 v72, v72, v5
    v_mad_u32_u24 v72, 12, v5, v72
    v_cvt_f32_u32 v204, v72
    v_mul_f32 v204, 0x3a000000, v204
    v_cos_f32 v196, v204
    v_sin_f32 v204, v204
    v_add_u32 v72, v72, v5
    v_cvt_f32_u32 v205, v72
    v_mul_f32 v205, 0x3a000000, v205
    v_cos_f32 v197, v205
    v_sin_f32 v205, v205
    v_add_u32 v72, v72, v5
    v_cvt_f32_u32 v206, v72
    v_mul_f32 v206, 0x3a000000, v206
    v_cos_f32 v198, v206
    v_sin_f32 v206, v206
    v_add_u32 v72, v72, v5
    v_cvt_f32_u32 v207, v72
    v_mul_f32 v207, 0x3a000000, v207
    v_cos_f32 v199, v207
    v_sin_f32 v207, v207
    v_add_u32 v72, v72, v5
    v_mov_b32 v72, s2
    v_cvt_f32_u32 v208, v72
    v_mul_f32 v208, 0x3acccccd, v208
    v_cos_f32 v209, v208
    v_sin_f32 v208, v208
    s_nop 0
    v_xor_b32 v208, 0x80000000, v208
    v_xor_b32 v209, 0x80000000, v209
    s_waitcnt lgkmcnt(0)
    v_perm_b32 v40, v25, v24, s13
    v_perm_b32 v44, v25, v24, s14
    v_perm_b32 v41, v27, v26, s13
    v_perm_b32 v45, v27, v26, s14
    v_perm_b32 v42, v29, v28, s13
    v_perm_b32 v46, v29, v28, s14
    v_perm_b32 v43, v31, v30, s13
    v_perm_b32 v47, v31, v30, s14
    v_perm_b32 v52, v33, v32, s13
    v_perm_b32 v56, v33, v32, s14
    v_perm_b32 v53, v35, v34, s13
    v_perm_b32 v57, v35, v34, s14
    v_perm_b32 v54, v37, v36, s13
    v_perm_b32 v58, v37, v36, s14
    v_perm_b32 v55, v39, v38, s13
    v_perm_b32 v59, v39, v38, s14
    v_alignbit_b32 v24, v8, v8, 16
    v_xor_b32 v24, 0x8000, v24
    v_alignbit_b32 v25, v9, v9, 16
    v_xor_b32 v25, 0x8000, v25
    v_alignbit_b32 v26, v10, v10, 16
    v_xor_b32 v26, 0x8000, v26
    v_alignbit_b32 v27, v11, v11, 16
    v_xor_b32 v27, 0x8000, v27
    v_alignbit_b32 v28, v12, v12, 16
    v_xor_b32 v28, 0x8000, v28
    v_alignbit_b32 v29, v13, v13, 16
    v_xor_b32 v29, 0x8000, v29
    v_alignbit_b32 v30, v14, v14, 16
    v_xor_b32 v30, 0x8000, v30
    v_alignbit_b32 v31, v15, v15, 16
    v_xor_b32 v31, 0x8000, v31
    v_alignbit_b32 v32, v16, v16, 16
    v_xor_b32 v32, 0x8000, v32
    v_alignbit_b32 v33, v17, v17, 16
    v_xor_b32 v33, 0x8000, v33
    v_alignbit_b32 v34, v18, v18, 16
    v_xor_b32 v34, 0x8000, v34
    v_alignbit_b32 v35, v19, v19, 16
    v_xor_b32 v35, 0x8000, v35
    v_alignbit_b32 v36, v20, v20, 16
    v_xor_b32 v36, 0x8000, v36
    v_alignbit_b32 v37, v21, v21, 16
    v_xor_b32 v37, 0x8000, v37
    v_alignbit_b32 v38, v22, v22, 16
    v_xor_b32 v38, 0x8000, v38
    v_alignbit_b32 v39, v23, v23, 16
    v_xor_b32 v39, 0x8000, v39
    v_xor_b32 v48, 0x80008000, v44
    v_xor_b32 v49, 0x80008000, v45
    v_xor_b32 v50, 0x80008000, v46
    v_xor_b32 v51, 0x80008000, v47
    v_xor_b32 v60, 0x80008000, v56
    v_xor_b32 v61, 0x80008000, v57
    v_xor_b32 v62, 0x80008000, v58
    v_xor_b32 v63, 0x80008000, v59
    s_waitcnt vmcnt(5)
    s_barrier
    ds_read_b128 v[80:83], v68 offset:16384
    ds_read_b128 v[96:99], v68 offset:20480
    ds_read_b128 v[84:87], v69 offset:16384
    ds_read_b128 v[100:103], v69 offset:20480
    ds_read_b128 v[88:91], v70 offset:16384
    ds_read_b128 v[104:107], v70 offset:20480
    ds_read_b128 v[92:95], v71 offset:16384
    ds_read_b128 v[108:111], v71 offset:20480
    ds_read_b128 v[112:115], v68 offset:24576
    ds_read_b128 v[128:131], v68 offset:28672
    ds_read_b128 v[116:119], v69 offset:24576
    ds_read_b128 v[132:135], v69 offset:28672
    ds_read_b128 v[120:123], v70 offset:24576
    ds_read_b128 v[136:139], v70 offset:28672
    ds_read_b128 v[124:127], v71 offset:24576
    s_waitcnt lgkmcnt(7)
    ds_read_b128 v[140:143], v71 offset:28672
    v_mfma_f32_16x16x32_f16 v[216:219], v[80:83], v[8:11], 0
    v_mfma_f32_16x16x32_f16 v[220:223], v[80:83], v[24:27], 0
    v_mfma_f32_16x16x32_f16 v[224:227], v[96:99], v[8:11], 0
    v_mfma_f32_16x16x32_f16 v[228:231], v[96:99], v[24:27], 0
    v_mfma_f32_16x16x32_f16 v[216:219], v[84:87], v[12:15], v[216:219]
    v_mfma_f32_16x16x32_f16 v[220:223], v[84:87], v[28:31], v[220:223]
    v_mfma_f32_16x16x32_f16 v[224:227], v[100:103], v[12:15], v[224:227]
    v_mfma_f32_16x16x32_f16 v[228:231], v[100:103], v[28:31], v[228:231]
    v_mfma_f32_16x16x32_f16 v[216:219], v[88:91], v[16:19], v[216:219]
    v_mfma_f32_16x16x32_f16 v[220:223], v[88:91], v[32:35], v[220:223]
    v_mfma_f32_16x16x32_f16 v[224:227], v[104:107], v[16:19], v[224:227]
    v_mfma_f32_16x16x32_f16 v[228:231], v[104:107], v[32:35], v[228:231]
    v_mfma_f32_16x16x32_f16 v[216:219], v[92:95], v[20:23], v[216:219]
    v_mfma_f32_16x16x32_f16 v[220:223], v[92:95], v[36:39], v[220:223]
    v_mfma_f32_16x16x32_f16 v[224:227], v[108:111], v[20:23], v[224:227]
    v_mfma_f32_16x16x32_f16 v[228:231], v[108:111], v[36:39], v[228:231]
    s_waitcnt lgkmcnt(0)
    v_xor_b32 v112, 0x80000000, v112
    v_xor_b32 v113, 0x80000000, v113
    v_xor_b32 v114, 0x80000000, v114
    v_xor_b32 v115, 0x80000000, v115
    v_xor_b32 v116, 0x80000000, v116
    v_xor_b32 v117, 0x80000000, v117
    v_xor_b32 v118, 0x80000000, v118
    v_xor_b32 v119, 0x80000000, v119
    v_xor_b32 v120, 0x80000000, v120
    v_xor_b32 v121, 0x80000000, v121
    v_xor_b32 v122, 0x80000000, v122
    v_xor_b32 v123, 0x80000000, v123
    v_xor_b32 v124, 0x80000000, v124
    v_xor_b32 v125, 0x80000000, v125
    v_xor_b32 v126, 0x80000000, v126
    v_xor_b32 v127, 0x80000000, v127
    v_xor_b32 v128, 0x80000000, v128
    v_xor_b32 v129, 0x80000000, v129
    v_xor_b32 v130, 0x80000000, v130
    v_xor_b32 v131, 0x80000000, v131
    v_xor_b32 v132, 0x80000000, v132
    v_xor_b32 v133, 0x80000000, v133
    v_xor_b32 v134, 0x80000000, v134
    v_xor_b32 v135, 0x80000000, v135
    v_xor_b32 v136, 0x80000000, v136
    v_xor_b32 v137, 0x80000000, v137
    v_xor_b32 v138, 0x80000000, v138
    v_xor_b32 v139, 0x80000000, v139
    v_xor_b32 v140, 0x80000000, v140
    v_xor_b32 v141, 0x80000000, v141
    v_xor_b32 v142, 0x80000000, v142
    v_xor_b32 v143, 0x80000000, v143
    v_mfma_f32_16x16x32_f16 v[232:235], v[112:115], v[8:11], 0
    v_mfma_f32_16x16x32_f16 v[236:239], v[112:115], v[24:27], 0
    v_mfma_f32_16x16x32_f16 v[240:243], v[128:131], v[8:11], 0
    v_mfma_f32_16x16x32_f16 v[244:247], v[128:131], v[24:27], 0
    v_mfma_f32_16x16x32_f16 v[232:235], v[116:119], v[12:15], v[232:235]
    v_mfma_f32_16x16x32_f16 v[236:239], v[116:119], v[28:31], v[236:239]
    v_mfma_f32_16x16x32_f16 v[240:243], v[132:135], v[12:15], v[240:243]
    v_mfma_f32_16x16x32_f16 v[244:247], v[132:135], v[28:31], v[244:247]
    v_mfma_f32_16x16x32_f16 v[232:235], v[120:123], v[16:19], v[232:235]
    v_mfma_f32_16x16x32_f16 v[236:239], v[120:123], v[32:35], v[236:239]
    v_mfma_f32_16x16x32_f16 v[240:243], v[136:139], v[16:19], v[240:243]
    v_mfma_f32_16x16x32_f16 v[244:247], v[136:139], v[32:35], v[244:247]
    v_mfma_f32_16x16x32_f16 v[232:235], v[124:127], v[20:23], v[232:235]
    v_mfma_f32_16x16x32_f16 v[236:239], v[124:127], v[36:39], v[236:239]
    v_mfma_f32_16x16x32_f16 v[240:243], v[140:143], v[20:23], v[240:243]
    v_mfma_f32_16x16x32_f16 v[244:247], v[140:143], v[36:39], v[244:247]
    s_waitcnt vmcnt(4)
    v_max_u32 v148, v148, v149
    v_max3_u32 v144, v148, v150, v151
    s_nop 1
    v_max_u32_dpp v144, v144, v144 quad_perm:[1,0,3,2] row_mask:0xf bank_mask:0xf
    s_nop 1
    v_max_u32_dpp v144, v144, v144 quad_perm:[2,3,0,1] row_mask:0xf bank_mask:0xf
    s_nop 1
    v_max_u32_dpp v144, v144, v144 row_half_mirror row_mask:0xf bank_mask:0xf
    s_nop 1
    v_max_u32_dpp v144, v144, v144 row_mirror row_mask:0xf bank_mask:0xf
    v_mov_b32 v152, v144
    s_nop 1
    v_permlane16_swap_b32 v144, v152
    v_max_u32 v144, v144, v152
    v_mov_b32 v152, v144
    s_nop 1
    v_permlane32_swap_b32 v144, v152
    v_max_u32 v144, v144, v152
    v_lshrrev_b32 v144, 7, v144
    v_max_u32 v144, 8, v144
    v_min_u32 v144, 0xfa, v144
    v_sub_u32 v212, 252, v144
    v_lshlrev_b32 v212, 23, v212
    v_mul_f32 v210, v208, v212
    v_mul_f32 v211, v209, v212
    v_mul_f32 v248, v216, v192
    v_mul_f32 v252, v220, v192
    v_fmac_f32 v248, v220, v200
    v_fma_f32 v252, -v216, v200, v252
    v_mul_f32 v249, v217, v193
    v_mul_f32 v253, v221, v193
    v_fmac_f32 v249, v221, v201
    v_fma_f32 v253, -v217, v201, v253
    v_mul_f32 v250, v218, v194
    v_mul_f32 v254, v222, v194
    v_fmac_f32 v250, v222, v202
    v_fma_f32 v254, -v218, v202, v254
    v_mul_f32 v251, v219, v195
    v_mul_f32 v255, v223, v195
    v_fmac_f32 v251, v223, v203
    v_fma_f32 v255, -v219, v203, v255
    v_cvt_pk_f16_f32 v80, v248, v249
    v_cvt_pk_f16_f32 v81, v250, v251
    v_cvt_pk_f16_f32 v84, v252, v253
    v_cvt_pk_f16_f32 v85, v254, v255
    v_mul_f32 v248, v224, v196
    v_mul_f32 v252, v228, v196
    v_fmac_f32 v248, v228, v204
    v_fma_f32 v252, -v224, v204, v252
    v_mul_f32 v249, v225, v197
    v_mul_f32 v253, v229, v197
    v_fmac_f32 v249, v229, v205
    v_fma_f32 v253, -v225, v205, v253
    v_mul_f32 v250, v226, v198
    v_mul_f32 v254, v230, v198
    v_fmac_f32 v250, v230, v206
    v_fma_f32 v254, -v226, v206, v254
    v_mul_f32 v251, v227, v199
    v_mul_f32 v255, v231, v199
    v_fmac_f32 v251, v231, v207
    v_fma_f32 v255, -v227, v207, v255
    v_cvt_pk_f16_f32 v82, v248, v249
    v_cvt_pk_f16_f32 v83, v250, v251
    v_cvt_pk_f16_f32 v86, v252, v253
    v_cvt_pk_f16_f32 v87, v254, v255
    v_mfma_f32_16x16x32_f16 v[216:219], v[40:43], v[80:83], 0
    s_nop 0
    v_mfma_f32_16x16x32_f16 v[220:223], v[40:43], v[84:87], 0
    v_mfma_f32_16x16x32_f16 v[224:227], v[52:55], v[80:83], 0
    v_mfma_f32_16x16x32_f16 v[228:231], v[52:55], v[84:87], 0
    v_mfma_f32_16x16x32_f16 v[216:219], v[44:47], v[84:87], v[216:219]
    v_mfma_f32_16x16x32_f16 v[220:223], v[48:51], v[80:83], v[220:223]
    v_mfma_f32_16x16x32_f16 v[224:227], v[56:59], v[84:87], v[224:227]
    v_mfma_f32_16x16x32_f16 v[228:231], v[60:63], v[80:83], v[228:231]
    v_mul_f32 v248, v232, v192
    v_mul_f32 v252, v236, v192
    v_fmac_f32 v248, v236, v200
    v_fma_f32 v252, -v232, v200, v252
    v_mul_f32 v249, v233, v193
    v_mul_f32 v253, v237, v193
    v_fmac_f32 v249, v237, v201
    v_fma_f32 v253, -v233, v201, v253
    v_mul_f32 v250, v234, v194
    v_mul_f32 v254, v238, v194
    v_fmac_f32 v250, v238, v202
    v_fma_f32 v254, -v234, v202, v254
    v_mul_f32 v251, v235, v195
    v_mul_f32 v255, v239, v195
    v_fmac_f32 v251, v239, v203
    v_fma_f32 v255, -v235, v203, v255
    v_cvt_pk_f16_f32 v112, v248, v249
    v_cvt_pk_f16_f32 v113, v250, v251
    v_cvt_pk_f16_f32 v116, v252, v253
    v_cvt_pk_f16_f32 v117, v254, v255
    v_mul_f32 v248, v240, v196
    v_mul_f32 v252, v244, v196
    v_fmac_f32 v248, v244, v204
    v_fma_f32 v252, -v240, v204, v252
    v_mul_f32 v249, v241, v197
    v_mul_f32 v253, v245, v197
    v_fmac_f32 v249, v245, v205
    v_fma_f32 v253, -v241, v205, v253
    v_mul_f32 v250, v242, v198
    v_mul_f32 v254, v246, v198
    v_fmac_f32 v250, v246, v206
    v_fma_f32 v254, -v242, v206, v254
    v_mul_f32 v251, v243, v199
    v_mul_f32 v255, v247, v199
    v_fmac_f32 v251, v247, v207
    v_fma_f32 v255, -v243, v207, v255
    v_cvt_pk_f16_f32 v114, v248, v249
    v_cvt_pk_f16_f32 v115, v250, v251
    v_cvt_pk_f16_f32 v118, v252, v253
    v_cvt_pk_f16_f32 v119, v254, v255
    v_mfma_f32_16x16x32_f16 v[232:235], v[40:43], v[112:115], 0
    s_nop 0
    v_mfma_f32_16x16x32_f16 v[236:239], v[40:43], v[116:119], 0
    v_mfma_f32_16x16x32_f16 v[240:243], v[52:55], v[112:115], 0
    v_mfma_f32_16x16x32_f16 v[244:247], v[52:55], v[116:119], 0
    v_mfma_f32_16x16x32_f16 v[232:235], v[44:47], v[116:119], v[232:235]
    v_mfma_f32_16x16x32_f16 v[236:239], v[48:51], v[112:115], v[236:239]
    v_mfma_f32_16x16x32_f16 v[240:243], v[56:59], v[116:119], v[240:243]
    v_mfma_f32_16x16x32_f16 v[244:247], v[60:63], v[112:115], v[244:247]
    v_add_u32 v78, 0, v2
    v_add_u32 v73, s4, v4
    v_mul_u32_u24 v72, v73, v78
    v_cvt_f32_u32 v120, v72
    v_mul_f32 v120, 0x3a000000, v120
    v_cos_f32 v88, v120
    v_sin_f32 v120, v120
    v_add_u32 v72, v72, v78
    v_cvt_f32_u32 v121, v72
    v_mul_f32 v121, 0x3a000000, v121
    v_cos_f32 v89, v121
    v_sin_f32 v121, v121
    v_add_u32 v72, v72, v78
    v_cvt_f32_u32 v122, v72
    v_mul_f32 v122, 0x3a000000, v122
    v_cos_f32 v90, v122
    v_sin_f32 v122, v122
    v_add_u32 v72, v72, v78
    v_cvt_f32_u32 v123, v72
    v_mul_f32 v123, 0x3a000000, v123
    v_cos_f32 v91, v123
    v_sin_f32 v123, v123
    v_add_u32 v78, 16, v2
    v_add_u32 v73, s4, v4
    v_mul_u32_u24 v72, v73, v78
    v_cvt_f32_u32 v124, v72
    v_mul_f32 v124, 0x3a000000, v124
    v_cos_f32 v92, v124
    v_sin_f32 v124, v124
    v_add_u32 v72, v72, v78
    v_cvt_f32_u32 v125, v72
    v_mul_f32 v125, 0x3a000000, v125
    v_cos_f32 v93, v125
    v_sin_f32 v125, v125
    v_add_u32 v72, v72, v78
    v_cvt_f32_u32 v126, v72
    v_mul_f32 v126, 0x3a000000, v126
    v_cos_f32 v94, v126
    v_sin_f32 v126, v126
    v_add_u32 v72, v72, v78
    v_cvt_f32_u32 v127, v72
    v_mul_f32 v127, 0x3a000000, v127
    v_cos_f32 v95, v127
    v_sin_f32 v127, v127
    s_mov_b32 s13, 0x05040100
    s_mov_b32 s14, 0x07060302
    v_perm_b32 v96, v9, v8, s13
    v_perm_b32 v104, v9, v8, s14
    v_perm_b32 v128, v25, v24, s13
    v_perm_b32 v97, v11, v10, s13
    v_perm_b32 v105, v11, v10, s14
    v_perm_b32 v129, v27, v26, s13
    v_perm_b32 v98, v13, v12, s13
    v_perm_b32 v106, v13, v12, s14
    v_perm_b32 v130, v29, v28, s13
    v_perm_b32 v99, v15, v14, s13
    v_perm_b32 v107, v15, v14, s14
    v_perm_b32 v131, v31, v30, s13
    v_perm_b32 v100, v17, v16, s13
    v_perm_b32 v108, v17, v16, s14
    v_perm_b32 v132, v33, v32, s13
    v_perm_b32 v101, v19, v18, s13
    v_perm_b32 v109, v19, v18, s14
    v_perm_b32 v133, v35, v34, s13
    v_perm_b32 v102, v21, v20, s13
    v_perm_b32 v110, v21, v20, s14
    v_perm_b32 v134, v37, v36, s13
    v_perm_b32 v103, v23, v22, s13
    v_perm_b32 v111, v23, v22, s14
    v_perm_b32 v135, v39, v38, s13
    s_waitcnt vmcnt(0)
    s_cmp_eq_u32 s2, 0
    s_nop 2
    s_cbranch_scc1 k2_z0
    v_lshlrev_b32 v136, 16, v156
    v_and_b32 v137, 0xffff0000, v156
    v_lshlrev_b32 v138, 16, v164
    v_and_b32 v139, 0xffff0000, v164
    v_add_f32 v192, v216, v232
    v_add_f32 v193, v220, v236
    v_sub_f32 v194, v216, v232
    v_sub_f32 v195, v220, v236
    v_mul_f32 v196, v210, v194
    v_mul_f32 v197, v210, v195
    v_fma_f32 v196, -v211, v195, v196
    v_fmac_f32 v197, v211, v194
    v_fma_f32 v198, v212, v192, v196
    v_fma_f32 v199, v212, v193, v197
    v_fma_f32 v200, v212, v192, -v196
    v_fma_f32 v201, v212, v193, -v197
    v_mul_f32 v202, v198, v136
    v_mul_f32 v203, v198, v137
    v_mul_f32 v204, v200, v138
    v_mul_f32 v205, v201, v138
    v_fma_f32 v202, -v199, v137, v202
    v_fmac_f32 v203, v199, v136
    v_fmac_f32 v204, v201, v139
    v_fma_f32 v205, -v200, v139, v205
    v_add_f32 v192, v202, v204
    v_add_f32 v193, v203, v205
    v_sub_f32 v194, v202, v204
    v_sub_f32 v195, v203, v205
    v_mul_f32 v196, v208, v194
    v_mul_f32 v197, v208, v195
    v_fmac_f32 v196, v209, v195
    v_fma_f32 v197, -v209, v194, v197
    v_add_f32 v216, v192, v196
    v_add_f32 v220, v193, v197
    v_sub_f32 v232, v192, v196
    v_sub_f32 v236, v193, v197
    v_lshlrev_b32 v136, 16, v157
    v_and_b32 v137, 0xffff0000, v157
    v_lshlrev_b32 v138, 16, v165
    v_and_b32 v139, 0xffff0000, v165
    v_add_f32 v192, v217, v233
    v_add_f32 v193, v221, v237
    v_sub_f32 v194, v217, v233
    v_sub_f32 v195, v221, v237
    v_mul_f32 v196, v210, v194
    v_mul_f32 v197, v210, v195
    v_fma_f32 v196, -v211, v195, v196
    v_fmac_f32 v197, v211, v194
    v_fma_f32 v198, v212, v192, v196
    v_fma_f32 v199, v212, v193, v197
    v_fma_f32 v200, v212, v192, -v196
    v_fma_f32 v201, v212, v193, -v197
    v_mul_f32 v202, v198, v136
    v_mul_f32 v203, v198, v137
    v_mul_f32 v204, v200, v138
    v_mul_f32 v205, v201, v138
    v_fma_f32 v202, -v199, v137, v202
    v_fmac_f32 v203, v199, v136
    v_fmac_f32 v204, v201, v139
    v_fma_f32 v205, -v200, v139, v205
    v_add_f32 v192, v202, v204
    v_add_f32 v193, v203, v205
    v_sub_f32 v194, v202, v204
    v_sub_f32 v195, v203, v205
    v_mul_f32 v196, v208, v194
    v_mul_f32 v197, v208, v195
    v_fmac_f32 v196, v209, v195
    v_fma_f32 v197, -v209, v194, v197
    v_add_f32 v217, v192, v196
    v_add_f32 v221, v193, v197
    v_sub_f32 v233, v192, v196
    v_sub_f32 v237, v193, v197
    v_lshlrev_b32 v136, 16, v158
    v_and_b32 v137, 0xffff0000, v158
    v_lshlrev_b32 v138, 16, v166
    v_and_b32 v139, 0xffff0000, v166
    v_add_f32 v192, v218, v234
    v_add_f32 v193, v222, v238
    v_sub_f32 v194, v218, v234
    v_sub_f32 v195, v222, v238
    v_mul_f32 v196, v210, v194
    v_mul_f32 v197, v210, v195
    v_fma_f32 v196, -v211, v195, v196
    v_fmac_f32 v197, v211, v194
    v_fma_f32 v198, v212, v192, v196
    v_fma_f32 v199, v212, v193, v197
    v_fma_f32 v200, v212, v192, -v196
    v_fma_f32 v201, v212, v193, -v197
    v_mul_f32 v202, v198, v136
    v_mul_f32 v203, v198, v137
    v_mul_f32 v204, v200, v138
    v_mul_f32 v205, v201, v138
    v_fma_f32 v202, -v199, v137, v202
    v_fmac_f32 v203, v199, v136
    v_fmac_f32 v204, v201, v139
    v_fma_f32 v205, -v200, v139, v205
    v_add_f32 v192, v202, v204
    v_add_f32 v193, v203, v205
    v_sub_f32 v194, v202, v204
    v_sub_f32 v195, v203, v205
    v_mul_f32 v196, v208, v194
    v_mul_f32 v197, v208, v195
    v_fmac_f32 v196, v209, v195
    v_fma_f32 v197, -v209, v194, v197
    v_add_f32 v218, v192, v196
    v_add_f32 v222, v193, v197
    v_sub_f32 v234, v192, v196
    v_sub_f32 v238, v193, v197
    v_lshlrev_b32 v136, 16, v159
    v_and_b32 v137, 0xffff0000, v159
    v_lshlrev_b32 v138, 16, v167
    v_and_b32 v139, 0xffff0000, v167
    v_add_f32 v192, v219, v235
    v_add_f32 v193, v223, v239
    v_sub_f32 v194, v219, v235
    v_sub_f32 v195, v223, v239
    v_mul_f32 v196, v210, v194
    v_mul_f32 v197, v210, v195
    v_fma_f32 v196, -v211, v195, v196
    v_fmac_f32 v197, v211, v194
    v_fma_f32 v198, v212, v192, v196
    v_fma_f32 v199, v212, v193, v197
    v_fma_f32 v200, v212, v192, -v196
    v_fma_f32 v201, v212, v193, -v197
    v_mul_f32 v202, v198, v136
    v_mul_f32 v203, v198, v137
    v_mul_f32 v204, v200, v138
    v_mul_f32 v205, v201, v138
    v_fma_f32 v202, -v199, v137, v202
    v_fmac_f32 v203, v199, v136
    v_fmac_f32 v204, v201, v139
    v_fma_f32 v205, -v200, v139, v205
    v_add_f32 v192, v202, v204
    v_add_f32 v193, v203, v205
    v_sub_f32 v194, v202, v204
    v_sub_f32 v195, v203, v205
    v_mul_f32 v196, v208, v194
    v_mul_f32 v197, v208, v195
    v_fmac_f32 v196, v209, v195
    v_fma_f32 v197, -v209, v194, v197
    v_add_f32 v219, v192, v196
    v_add_f32 v223, v193, v197
    v_sub_f32 v235, v192, v196
    v_sub_f32 v239, v193, v197
    v_lshlrev_b32 v136, 16, v160
    v_and_b32 v137, 0xffff0000, v160
    v_lshlrev_b32 v138, 16, v168
    v_and_b32 v139, 0xffff0000, v168
    v_add_f32 v192, v224, v240
    v_add_f32 v193, v228, v244
    v_sub_f32 v194, v224, v240
    v_sub_f32 v195, v228, v244
    v_mul_f32 v196, v210, v194
    v_mul_f32 v197, v210, v195
    v_fma_f32 v196, -v211, v195, v196
    v_fmac_f32 v197, v211, v194
    v_fma_f32 v198, v212, v192, v196
    v_fma_f32 v199, v212, v193, v197
    v_fma_f32 v200, v212, v192, -v196
    v_fma_f32 v201, v212, v193, -v197
    v_mul_f32 v202, v198, v136
    v_mul_f32 v203, v198, v137
    v_mul_f32 v204, v200, v138
    v_mul_f32 v205, v201, v138
    v_fma_f32 v202, -v199, v137, v202
    v_fmac_f32 v203, v199, v136
    v_fmac_f32 v204, v201, v139
    v_fma_f32 v205, -v200, v139, v205
    v_add_f32 v192, v202, v204
    v_add_f32 v193, v203, v205
    v_sub_f32 v194, v202, v204
    v_sub_f32 v195, v203, v205
    v_mul_f32 v196, v208, v194
    v_mul_f32 v197, v208, v195
    v_fmac_f32 v196, v209, v195
    v_fma_f32 v197, -v209, v194, v197
    v_add_f32 v224, v192, v196
    v_add_f32 v228, v193, v197
    v_sub_f32 v240, v192, v196
    v_sub_f32 v244, v193, v197
    v_lshlrev_b32 v136, 16, v161
    v_and_b32 v137, 0xffff0000, v161
    v_lshlrev_b32 v138, 16, v169
    v_and_b32 v139, 0xffff0000, v169
    v_add_f32 v192, v225, v241
    v_add_f32 v193, v229, v245
    v_sub_f32 v194, v225, v241
    v_sub_f32 v195, v229, v245
    v_mul_f32 v196, v210, v194
    v_mul_f32 v197, v210, v195
    v_fma_f32 v196, -v211, v195, v196
    v_fmac_f32 v197, v211, v194
    v_fma_f32 v198, v212, v192, v196
    v_fma_f32 v199, v212, v193, v197
    v_fma_f32 v200, v212, v192, -v196
    v_fma_f32 v201, v212, v193, -v197
    v_mul_f32 v202, v198, v136
    v_mul_f32 v203, v198, v137
    v_mul_f32 v204, v200, v138
    v_mul_f32 v205, v201, v138
    v_fma_f32 v202, -v199, v137, v202
    v_fmac_f32 v203, v199, v136
    v_fmac_f32 v204, v201, v139
    v_fma_f32 v205, -v200, v139, v205
    v_add_f32 v192, v202, v204
    v_add_f32 v193, v203, v205
    v_sub_f32 v194, v202, v204
    v_sub_f32 v195, v203, v205
    v_mul_f32 v196, v208, v194
    v_mul_f32 v197, v208, v195
    v_fmac_f32 v196, v209, v195
    v_fma_f32 v197, -v209, v194, v197
    v_add_f32 v225, v192, v196
    v_add_f32 v229, v193, v197
    v_sub_f32 v241, v192, v196
    v_sub_f32 v245, v193, v197
    v_lshlrev_b32 v136, 16, v162
    v_and_b32 v137, 0xffff0000, v162
    v_lshlrev_b32 v138, 16, v170
    v_and_b32 v139, 0xffff0000, v170
    v_add_f32 v192, v226, v242
    v_add_f32 v193, v230, v246
    v_sub_f32 v194, v226, v242
    v_sub_f32 v195, v230, v246
    v_mul_f32 v196, v210, v194
    v_mul_f32 v197, v210, v195
    v_fma_f32 v196, -v211, v195, v196
    v_fmac_f32 v197, v211, v194
    v_fma_f32 v198, v212, v192, v196
    v_fma_f32 v199, v212, v193, v197
    v_fma_f32 v200, v212, v192, -v196
    v_fma_f32 v201, v212, v193, -v197
    v_mul_f32 v202, v198, v136
    v_mul_f32 v203, v198, v137
    v_mul_f32 v204, v200, v138
    v_mul_f32 v205, v201, v138
    v_fma_f32 v202, -v199, v137, v202
    v_fmac_f32 v203, v199, v136
    v_fmac_f32 v204, v201, v139
    v_fma_f32 v205, -v200, v139, v205
    v_add_f32 v192, v202, v204
    v_add_f32 v193, v203, v205
    v_sub_f32 v194, v202, v204
    v_sub_f32 v195, v203, v205
    v_mul_f32 v196, v208, v194
    v_mul_f32 v197, v208, v195
    v_fmac_f32 v196, v209, v195
    v_fma_f32 v197, -v209, v194, v197
    v_add_f32 v226, v192, v196
    v_add_f32 v230, v193, v197
    v_sub_f32 v242, v192, v196
    v_sub_f32 v246, v193, v197
    v_lshlrev_b32 v136, 16, v163
    v_and_b32 v137, 0xffff0000, v163
    v_lshlrev_b32 v138, 16, v171
    v_and_b32 v139, 0xffff0000, v171
    v_add_f32 v192, v227, v243
    v_add_f32 v193, v231, v247
    v_sub_f32 v194, v227, v243
    v_sub_f32 v195, v231, v247
    v_mul_f32 v196, v210, v194
    v_mul_f32 v197, v210, v195
    v_fma_f32 v196, -v211, v195, v196
    v_fmac_f32 v197, v211, v194
    v_fma_f32 v198, v212, v192, v196
    v_fma_f32 v199, v212, v193, v197
    v_fma_f32 v200, v212, v192, -v196
    v_fma_f32 v201, v212, v193, -v197
    v_mul_f32 v202, v198, v136
    v_mul_f32 v203, v198, v137
    v_mul_f32 v204, v200, v138
    v_mul_f32 v205, v201, v138
    v_fma_f32 v202, -v199, v137, v202
    v_fmac_f32 v203, v199, v136
    v_fmac_f32 v204, v201, v139
    v_fma_f32 v205, -v200, v139, v205
    v_add_f32 v192, v202, v204
    v_add_f32 v193, v203, v205
    v_sub_f32 v194, v202, v204
    v_sub_f32 v195, v203, v205
    v_mul_f32 v196, v208, v194
    v_mul_f32 v197, v208, v195
    v_fmac_f32 v196, v209, v195
    v_fma_f32 v197, -v209, v194, v197
    v_add_f32 v227, v192, v196
    v_add_f32 v231, v193, v197
    v_sub_f32 v243, v192, v196
    v_sub_f32 v247, v193, v197
    s_nop 4
    s_branch k2_nz
    s_nop 0
k2_z0:
    s_mov_b32 s11, 1318912
    s_mov_b32 s12, 2646016
    buffer_load_dwordx4 v[172:175], v188, s[28:31], s11 offen
    buffer_load_dwordx4 v[176:179], v188, s[28:31], s11 offen offset:16
    buffer_load_dwordx4 v[180:183], v188, s[28:31], s12 offen
    buffer_load_dwordx4 v[184:187], v188, s[28:31], s12 offen offset:16
    s_waitcnt vmcnt(0)
    v_lshlrev_b32 v136, 16, v156
    v_and_b32 v137, 0xffff0000, v156
    v_lshlrev_b32 v138, 16, v164
    v_and_b32 v139, 0xffff0000, v164
    v_lshlrev_b32 v74, 16, v172
    v_and_b32 v75, 0xffff0000, v172
    v_add_f32 v136, v136, v74
    v_sub_f32 v137, v137, v75
    v_mul_f32 v136, 0.5, v136
    v_mul_f32 v137, 0.5, v137
    v_lshlrev_b32 v74, 16, v180
    v_and_b32 v75, 0xffff0000, v180
    v_add_f32 v138, v138, v74
    v_sub_f32 v139, v139, v75
    v_mul_f32 v138, 0.5, v138
    v_mul_f32 v139, 0.5, v139
    v_add_f32 v192, v216, v232
    v_add_f32 v193, v220, v236
    v_sub_f32 v194, v216, v232
    v_sub_f32 v195, v220, v236
    v_mul_f32 v196, v210, v194
    v_mul_f32 v197, v210, v195
    v_fma_f32 v196, -v211, v195, v196
    v_fmac_f32 v197, v211, v194
    v_fma_f32 v198, v212, v192, v196
    v_fma_f32 v199, v212, v193, v197
    v_fma_f32 v200, v212, v192, -v196
    v_fma_f32 v201, v212, v193, -v197
    v_mul_f32 v202, v198, v136
    v_mul_f32 v203, v198, v137
    v_mul_f32 v204, v200, v138
    v_mul_f32 v205, v201, v138
    v_fma_f32 v202, -v199, v137, v202
    v_fmac_f32 v203, v199, v136
    v_fmac_f32 v204, v201, v139
    v_fma_f32 v205, -v200, v139, v205
    v_add_f32 v192, v202, v204
    v_add_f32 v193, v203, v205
    v_sub_f32 v194, v202, v204
    v_sub_f32 v195, v203, v205
    v_mul_f32 v196, v208, v194
    v_mul_f32 v197, v208, v195
    v_fmac_f32 v196, v209, v195
    v_fma_f32 v197, -v209, v194, v197
    v_add_f32 v216, v192, v196
    v_add_f32 v220, v193, v197
    v_sub_f32 v232, v192, v196
    v_sub_f32 v236, v193, v197
    v_lshlrev_b32 v136, 16, v157
    v_and_b32 v137, 0xffff0000, v157
    v_lshlrev_b32 v138, 16, v165
    v_and_b32 v139, 0xffff0000, v165
    v_lshlrev_b32 v74, 16, v173
    v_and_b32 v75, 0xffff0000, v173
    v_add_f32 v136, v136, v74
    v_sub_f32 v137, v137, v75
    v_mul_f32 v136, 0.5, v136
    v_mul_f32 v137, 0.5, v137
    v_lshlrev_b32 v74, 16, v181
    v_and_b32 v75, 0xffff0000, v181
    v_add_f32 v138, v138, v74
    v_sub_f32 v139, v139, v75
    v_mul_f32 v138, 0.5, v138
    v_mul_f32 v139, 0.5, v139
    v_add_f32 v192, v217, v233
    v_add_f32 v193, v221, v237
    v_sub_f32 v194, v217, v233
    v_sub_f32 v195, v221, v237
    v_mul_f32 v196, v210, v194
    v_mul_f32 v197, v210, v195
    v_fma_f32 v196, -v211, v195, v196
    v_fmac_f32 v197, v211, v194
    v_fma_f32 v198, v212, v192, v196
    v_fma_f32 v199, v212, v193, v197
    v_fma_f32 v200, v212, v192, -v196
    v_fma_f32 v201, v212, v193, -v197
    v_mul_f32 v202, v198, v136
    v_mul_f32 v203, v198, v137
    v_mul_f32 v204, v200, v138
    v_mul_f32 v205, v201, v138
    v_fma_f32 v202, -v199, v137, v202
    v_fmac_f32 v203, v199, v136
    v_fmac_f32 v204, v201, v139
    v_fma_f32 v205, -v200, v139, v205
    v_add_f32 v192, v202, v204
    v_add_f32 v193, v203, v205
    v_sub_f32 v194, v202, v204
    v_sub_f32 v195, v203, v205
    v_mul_f32 v196, v208, v194
    v_mul_f32 v197, v208, v195
    v_fmac_f32 v196, v209, v195
    v_fma_f32 v197, -v209, v194, v197
    v_add_f32 v217, v192, v196
    v_add_f32 v221, v193, v197
    v_sub_f32 v233, v192, v196
    v_sub_f32 v237, v193, v197
    v_lshlrev_b32 v136, 16, v158
    v_and_b32 v137, 0xffff0000, v158
    v_lshlrev_b32 v138, 16, v166
    v_and_b32 v139, 0xffff0000, v166
    v_lshlrev_b32 v74, 16, v174
    v_and_b32 v75, 0xffff0000, v174
    v_add_f32 v136, v136, v74
    v_sub_f32 v137, v137, v75
    v_mul_f32 v136, 0.5, v136
    v_mul_f32 v137, 0.5, v137
    v_lshlrev_b32 v74, 16, v182
    v_and_b32 v75, 0xffff0000, v182
    v_add_f32 v138, v138, v74
    v_sub_f32 v139, v139, v75
    v_mul_f32 v138, 0.5, v138
    v_mul_f32 v139, 0.5, v139
    v_add_f32 v192, v218, v234
    v_add_f32 v193, v222, v238
    v_sub_f32 v194, v218, v234
    v_sub_f32 v195, v222, v238
    v_mul_f32 v196, v210, v194
    v_mul_f32 v197, v210, v195
    v_fma_f32 v196, -v211, v195, v196
    v_fmac_f32 v197, v211, v194
    v_fma_f32 v198, v212, v192, v196
    v_fma_f32 v199, v212, v193, v197
    v_fma_f32 v200, v212, v192, -v196
    v_fma_f32 v201, v212, v193, -v197
    v_mul_f32 v202, v198, v136
    v_mul_f32 v203, v198, v137
    v_mul_f32 v204, v200, v138
    v_mul_f32 v205, v201, v138
    v_fma_f32 v202, -v199, v137, v202
    v_fmac_f32 v203, v199, v136
    v_fmac_f32 v204, v201, v139
    v_fma_f32 v205, -v200, v139, v205
    v_add_f32 v192, v202, v204
    v_add_f32 v193, v203, v205
    v_sub_f32 v194, v202, v204
    v_sub_f32 v195, v203, v205
    v_mul_f32 v196, v208, v194
    v_mul_f32 v197, v208, v195
    v_fmac_f32 v196, v209, v195
    v_fma_f32 v197, -v209, v194, v197
    v_add_f32 v218, v192, v196
    v_add_f32 v222, v193, v197
    v_sub_f32 v234, v192, v196
    v_sub_f32 v238, v193, v197
    v_lshlrev_b32 v136, 16, v159
    v_and_b32 v137, 0xffff0000, v159
    v_lshlrev_b32 v138, 16, v167
    v_and_b32 v139, 0xffff0000, v167
    v_lshlrev_b32 v74, 16, v175
    v_and_b32 v75, 0xffff0000, v175
    v_add_f32 v136, v136, v74
    v_sub_f32 v137, v137, v75
    v_mul_f32 v136, 0.5, v136
    v_mul_f32 v137, 0.5, v137
    v_lshlrev_b32 v74, 16, v183
    v_and_b32 v75, 0xffff0000, v183
    v_add_f32 v138, v138, v74
    v_sub_f32 v139, v139, v75
    v_mul_f32 v138, 0.5, v138
    v_mul_f32 v139, 0.5, v139
    v_add_f32 v192, v219, v235
    v_add_f32 v193, v223, v239
    v_sub_f32 v194, v219, v235
    v_sub_f32 v195, v223, v239
    v_mul_f32 v196, v210, v194
    v_mul_f32 v197, v210, v195
    v_fma_f32 v196, -v211, v195, v196
    v_fmac_f32 v197, v211, v194
    v_fma_f32 v198, v212, v192, v196
    v_fma_f32 v199, v212, v193, v197
    v_fma_f32 v200, v212, v192, -v196
    v_fma_f32 v201, v212, v193, -v197
    v_mul_f32 v202, v198, v136
    v_mul_f32 v203, v198, v137
    v_mul_f32 v204, v200, v138
    v_mul_f32 v205, v201, v138
    v_fma_f32 v202, -v199, v137, v202
    v_fmac_f32 v203, v199, v136
    v_fmac_f32 v204, v201, v139
    v_fma_f32 v205, -v200, v139, v205
    v_add_f32 v192, v202, v204
    v_add_f32 v193, v203, v205
    v_sub_f32 v194, v202, v204
    v_sub_f32 v195, v203, v205
    v_mul_f32 v196, v208, v194
    v_mul_f32 v197, v208, v195
    v_fmac_f32 v196, v209, v195
    v_fma_f32 v197, -v209, v194, v197
    v_add_f32 v219, v192, v196
    v_add_f32 v223, v193, v197
    v_sub_f32 v235, v192, v196
    v_sub_f32 v239, v193, v197
    v_lshlrev_b32 v136, 16, v160
    v_and_b32 v137, 0xffff0000, v160
    v_lshlrev_b32 v138, 16, v168
    v_and_b32 v139, 0xffff0000, v168
    v_lshlrev_b32 v74, 16, v176
    v_and_b32 v75, 0xffff0000, v176
    v_add_f32 v136, v136, v74
    v_sub_f32 v137, v137, v75
    v_mul_f32 v136, 0.5, v136
    v_mul_f32 v137, 0.5, v137
    v_lshlrev_b32 v74, 16, v184
    v_and_b32 v75, 0xffff0000, v184
    v_add_f32 v138, v138, v74
    v_sub_f32 v139, v139, v75
    v_mul_f32 v138, 0.5, v138
    v_mul_f32 v139, 0.5, v139
    v_add_f32 v192, v224, v240
    v_add_f32 v193, v228, v244
    v_sub_f32 v194, v224, v240
    v_sub_f32 v195, v228, v244
    v_mul_f32 v196, v210, v194
    v_mul_f32 v197, v210, v195
    v_fma_f32 v196, -v211, v195, v196
    v_fmac_f32 v197, v211, v194
    v_fma_f32 v198, v212, v192, v196
    v_fma_f32 v199, v212, v193, v197
    v_fma_f32 v200, v212, v192, -v196
    v_fma_f32 v201, v212, v193, -v197
    v_mul_f32 v202, v198, v136
    v_mul_f32 v203, v198, v137
    v_mul_f32 v204, v200, v138
    v_mul_f32 v205, v201, v138
    v_fma_f32 v202, -v199, v137, v202
    v_fmac_f32 v203, v199, v136
    v_fmac_f32 v204, v201, v139
    v_fma_f32 v205, -v200, v139, v205
    v_add_f32 v192, v202, v204
    v_add_f32 v193, v203, v205
    v_sub_f32 v194, v202, v204
    v_sub_f32 v195, v203, v205
    v_mul_f32 v196, v208, v194
    v_mul_f32 v197, v208, v195
    v_fmac_f32 v196, v209, v195
    v_fma_f32 v197, -v209, v194, v197
    v_add_f32 v224, v192, v196
    v_add_f32 v228, v193, v197
    v_sub_f32 v240, v192, v196
    v_sub_f32 v244, v193, v197
    v_lshlrev_b32 v136, 16, v161
    v_and_b32 v137, 0xffff0000, v161
    v_lshlrev_b32 v138, 16, v169
    v_and_b32 v139, 0xffff0000, v169
    v_lshlrev_b32 v74, 16, v177
    v_and_b32 v75, 0xffff0000, v177
    v_add_f32 v136, v136, v74
    v_sub_f32 v137, v137, v75
    v_mul_f32 v136, 0.5, v136
    v_mul_f32 v137, 0.5, v137
    v_lshlrev_b32 v74, 16, v185
    v_and_b32 v75, 0xffff0000, v185
    v_add_f32 v138, v138, v74
    v_sub_f32 v139, v139, v75
    v_mul_f32 v138, 0.5, v138
    v_mul_f32 v139, 0.5, v139
    v_add_f32 v192, v225, v241
    v_add_f32 v193, v229, v245
    v_sub_f32 v194, v225, v241
    v_sub_f32 v195, v229, v245
    v_mul_f32 v196, v210, v194
    v_mul_f32 v197, v210, v195
    v_fma_f32 v196, -v211, v195, v196
    v_fmac_f32 v197, v211, v194
    v_fma_f32 v198, v212, v192, v196
    v_fma_f32 v199, v212, v193, v197
    v_fma_f32 v200, v212, v192, -v196
    v_fma_f32 v201, v212, v193, -v197
    v_mul_f32 v202, v198, v136
    v_mul_f32 v203, v198, v137
    v_mul_f32 v204, v200, v138
    v_mul_f32 v205, v201, v138
    v_fma_f32 v202, -v199, v137, v202
    v_fmac_f32 v203, v199, v136
    v_fmac_f32 v204, v201, v139
    v_fma_f32 v205, -v200, v139, v205
    v_add_f32 v192, v202, v204
    v_add_f32 v193, v203, v205
    v_sub_f32 v194, v202, v204
    v_sub_f32 v195, v203, v205
    v_mul_f32 v196, v208, v194
    v_mul_f32 v197, v208, v195
    v_fmac_f32 v196, v209, v195
    v_fma_f32 v197, -v209, v194, v197
    v_add_f32 v225, v192, v196
    v_add_f32 v229, v193, v197
    v_sub_f32 v241, v192, v196
    v_sub_f32 v245, v193, v197
    v_lshlrev_b32 v136, 16, v162
    v_and_b32 v137, 0xffff0000, v162
    v_lshlrev_b32 v138, 16, v170
    v_and_b32 v139, 0xffff0000, v170
    v_lshlrev_b32 v74, 16, v178
    v_and_b32 v75, 0xffff0000, v178
    v_add_f32 v136, v136, v74
    v_sub_f32 v137, v137, v75
    v_mul_f32 v136, 0.5, v136
    v_mul_f32 v137, 0.5, v137
    v_lshlrev_b32 v74, 16, v186
    v_and_b32 v75, 0xffff0000, v186
    v_add_f32 v138, v138, v74
    v_sub_f32 v139, v139, v75
    v_mul_f32 v138, 0.5, v138
    v_mul_f32 v139, 0.5, v139
    v_add_f32 v192, v226, v242
    v_add_f32 v193, v230, v246
    v_sub_f32 v194, v226, v242
    v_sub_f32 v195, v230, v246
    v_mul_f32 v196, v210, v194
    v_mul_f32 v197, v210, v195
    v_fma_f32 v196, -v211, v195, v196
    v_fmac_f32 v197, v211, v194
    v_fma_f32 v198, v212, v192, v196
    v_fma_f32 v199, v212, v193, v197
    v_fma_f32 v200, v212, v192, -v196
    v_fma_f32 v201, v212, v193, -v197
    v_mul_f32 v202, v198, v136
    v_mul_f32 v203, v198, v137
    v_mul_f32 v204, v200, v138
    v_mul_f32 v205, v201, v138
    v_fma_f32 v202, -v199, v137, v202
    v_fmac_f32 v203, v199, v136
    v_fmac_f32 v204, v201, v139
    v_fma_f32 v205, -v200, v139, v205
    v_add_f32 v192, v202, v204
    v_add_f32 v193, v203, v205
    v_sub_f32 v194, v202, v204
    v_sub_f32 v195, v203, v205
    v_mul_f32 v196, v208, v194
    v_mul_f32 v197, v208, v195
    v_fmac_f32 v196, v209, v195
    v_fma_f32 v197, -v209, v194, v197
    v_add_f32 v226, v192, v196
    v_add_f32 v230, v193, v197
    v_sub_f32 v242, v192, v196
    v_sub_f32 v246, v193, v197
    v_lshlrev_b32 v136, 16, v163
    v_and_b32 v137, 0xffff0000, v163
    v_lshlrev_b32 v138, 16, v171
    v_and_b32 v139, 0xffff0000, v171
    v_lshlrev_b32 v74, 16, v179
    v_and_b32 v75, 0xffff0000, v179
    v_add_f32 v136, v136, v74
    v_sub_f32 v137, v137, v75
    v_mul_f32 v136, 0.5, v136
    v_mul_f32 v137, 0.5, v137
    v_lshlrev_b32 v74, 16, v187
    v_and_b32 v75, 0xffff0000, v187
    v_add_f32 v138, v138, v74
    v_sub_f32 v139, v139, v75
    v_mul_f32 v138, 0.5, v138
    v_mul_f32 v139, 0.5, v139
    v_add_f32 v192, v227, v243
    v_add_f32 v193, v231, v247
    v_sub_f32 v194, v227, v243
    v_sub_f32 v195, v231, v247
    v_mul_f32 v196, v210, v194
    v_mul_f32 v197, v210, v195
    v_fma_f32 v196, -v211, v195, v196
    v_fmac_f32 v197, v211, v194
    v_fma_f32 v198, v212, v192, v196
    v_fma_f32 v199, v212, v193, v197
    v_fma_f32 v200, v212, v192, -v196
    v_fma_f32 v201, v212, v193, -v197
    v_mul_f32 v202, v198, v136
    v_mul_f32 v203, v198, v137
    v_mul_f32 v204, v200, v138
    v_mul_f32 v205, v201, v138
    v_fma_f32 v202, -v199, v137, v202
    v_fmac_f32 v203, v199, v136
    v_fmac_f32 v204, v201, v139
    v_fma_f32 v205, -v200, v139, v205
    v_add_f32 v192, v202, v204
    v_add_f32 v193, v203, v205
    v_sub_f32 v194, v202, v204
    v_sub_f32 v195, v203, v205
    v_mul_f32 v196, v208, v194
    v_mul_f32 v197, v208, v195
    v_fmac_f32 v196, v209, v195
    v_fma_f32 v197, -v209, v194, v197
    v_add_f32 v227, v192, v196
    v_add_f32 v231, v193, v197
    v_sub_f32 v243, v192, v196
    v_sub_f32 v247, v193, v197
    s_nop 4
k2_nz:
    v_lshlrev_b32 v64, 4, v1
    s_lshr_b32 s15, s3, 1
    s_lshl_b32 s15, s15, 10
    s_and_b32 s24, s3, 1
    s_lshl_b32 s24, s24, 3
    s_add_u32 s15, s15, s24
    v_add_u32 v65, s15, v64
    v_cvt_pk_f16_f32 v80, v216, v217
    v_cvt_pk_f16_f32 v84, v220, v221
    v_cvt_pk_f16_f32 v81, v218, v219
    v_cvt_pk_f16_f32 v85, v222, v223
    v_cvt_pk_f16_f32 v82, v224, v225
    v_cvt_pk_f16_f32 v86, v228, v229
    v_cvt_pk_f16_f32 v83, v226, v227
    v_cvt_pk_f16_f32 v87, v230, v231
    s_nop 0
    v_mfma_f32_16x16x32_f16 v[216:219], v[80:83], v[40:43], 0
    v_mfma_f32_16x16x32_f16 v[220:223], v[80:83], v[44:47], 0
    v_mfma_f32_16x16x32_f16 v[224:227], v[80:83], v[52:55], 0
    v_mfma_f32_16x16x32_f16 v[228:231], v[80:83], v[56:59], 0
    v_mfma_f32_16x16x32_f16 v[216:219], v[84:87], v[48:51], v[216:219]
    v_mfma_f32_16x16x32_f16 v[220:223], v[84:87], v[40:43], v[220:223]
    v_mfma_f32_16x16x32_f16 v[224:227], v[84:87], v[60:63], v[224:227]
    v_mfma_f32_16x16x32_f16 v[228:231], v[84:87], v[52:55], v[228:231]
    v_cvt_pk_f16_f32 v112, v232, v233
    v_cvt_pk_f16_f32 v116, v236, v237
    v_cvt_pk_f16_f32 v113, v234, v235
    v_cvt_pk_f16_f32 v117, v238, v239
    v_cvt_pk_f16_f32 v114, v240, v241
    v_cvt_pk_f16_f32 v118, v244, v245
    v_cvt_pk_f16_f32 v115, v242, v243
    v_cvt_pk_f16_f32 v119, v246, v247
    s_nop 0
    v_mfma_f32_16x16x32_f16 v[232:235], v[112:115], v[40:43], 0
    v_mfma_f32_16x16x32_f16 v[236:239], v[112:115], v[44:47], 0
    v_mfma_f32_16x16x32_f16 v[240:243], v[112:115], v[52:55], 0
    v_mfma_f32_16x16x32_f16 v[244:247], v[112:115], v[56:59], 0
    v_mfma_f32_16x16x32_f16 v[232:235], v[116:119], v[48:51], v[232:235]
    v_mfma_f32_16x16x32_f16 v[236:239], v[116:119], v[40:43], v[236:239]
    v_mfma_f32_16x16x32_f16 v[240:243], v[116:119], v[60:63], v[240:243]
    v_mfma_f32_16x16x32_f16 v[244:247], v[116:119], v[52:55], v[244:247]
    v_mul_f32 v248, v216, v88
    v_mul_f32 v252, v220, v88
    v_fma_f32 v248, -v220, v120, v248
    v_fmac_f32 v252, v216, v120
    v_mul_f32 v249, v217, v89
    v_mul_f32 v253, v221, v89
    v_fma_f32 v249, -v221, v121, v249
    v_fmac_f32 v253, v217, v121
    v_mul_f32 v250, v218, v90
    v_mul_f32 v254, v222, v90
    v_fma_f32 v250, -v222, v122, v250
    v_fmac_f32 v254, v218, v122
    v_mul_f32 v251, v219, v91
    v_mul_f32 v255, v223, v91
    v_fma_f32 v251, -v223, v123, v251
    v_fmac_f32 v255, v219, v123
    v_cvt_pk_f16_f32 v216, v248, v249
    v_cvt_pk_f16_f32 v217, v250, v251
    v_cvt_pk_f16_f32 v218, v252, v253
    v_cvt_pk_f16_f32 v219, v254, v255
    ds_write_b64 v65, v[216:217] offset:0
    ds_write_b64 v65, v[218:219] offset:2048
    v_mul_f32 v248, v224, v92
    v_mul_f32 v252, v228, v92
    v_fma_f32 v248, -v228, v124, v248
    v_fmac_f32 v252, v224, v124
    v_mul_f32 v249, v225, v93
    v_mul_f32 v253, v229, v93
    v_fma_f32 v249, -v229, v125, v249
    v_fmac_f32 v253, v225, v125
    v_mul_f32 v250, v226, v94
    v_mul_f32 v254, v230, v94
    v_fma_f32 v250, -v230, v126, v250
    v_fmac_f32 v254, v226, v126
    v_mul_f32 v251, v227, v95
    v_mul_f32 v255, v231, v95
    v_fma_f32 v251, -v231, v127, v251
    v_fmac_f32 v255, v227, v127
    v_cvt_pk_f16_f32 v224, v248, v249
    v_cvt_pk_f16_f32 v225, v250, v251
    v_cvt_pk_f16_f32 v226, v252, v253
    v_cvt_pk_f16_f32 v227, v254, v255
    ds_write_b64 v65, v[224:225] offset:4096
    ds_write_b64 v65, v[226:227] offset:6144
    v_mul_f32 v248, v232, v88
    v_mul_f32 v252, v236, v88
    v_fma_f32 v248, -v236, v120, v248
    v_fmac_f32 v252, v232, v120
    v_mul_f32 v249, v233, v89
    v_mul_f32 v253, v237, v89
    v_fma_f32 v249, -v237, v121, v249
    v_fmac_f32 v253, v233, v121
    v_mul_f32 v250, v234, v90
    v_mul_f32 v254, v238, v90
    v_fma_f32 v250, -v238, v122, v250
    v_fmac_f32 v254, v234, v122
    v_mul_f32 v251, v235, v91
    v_mul_f32 v255, v239, v91
    v_fma_f32 v251, -v239, v123, v251
    v_fmac_f32 v255, v235, v123
    v_cvt_pk_f16_f32 v232, v248, v249
    v_cvt_pk_f16_f32 v233, v250, v251
    v_cvt_pk_f16_f32 v234, v252, v253
    v_cvt_pk_f16_f32 v235, v254, v255
    ds_write_b64 v65, v[232:233] offset:8192
    ds_write_b64 v65, v[234:235] offset:10240
    v_mul_f32 v248, v240, v92
    v_mul_f32 v252, v244, v92
    v_fma_f32 v248, -v244, v124, v248
    v_fmac_f32 v252, v240, v124
    v_mul_f32 v249, v241, v93
    v_mul_f32 v253, v245, v93
    v_fma_f32 v249, -v245, v125, v249
    v_fmac_f32 v253, v241, v125
    v_mul_f32 v250, v242, v94
    v_mul_f32 v254, v246, v94
    v_fma_f32 v250, -v246, v126, v250
    v_fmac_f32 v254, v242, v126
    v_mul_f32 v251, v243, v95
    v_mul_f32 v255, v247, v95
    v_fma_f32 v251, -v247, v127, v251
    v_fmac_f32 v255, v243, v127
    v_cvt_pk_f16_f32 v240, v248, v249
    v_cvt_pk_f16_f32 v241, v250, v251
    v_cvt_pk_f16_f32 v242, v252, v253
    v_cvt_pk_f16_f32 v243, v254, v255
    ds_write_b64 v65, v[240:241] offset:12288
    ds_write_b64 v65, v[242:243] offset:14336
    s_waitcnt lgkmcnt(0)
    s_barrier
    ds_read_b128 v[184:187], v64 offset:0
    ds_read_b128 v[180:183], v64 offset:1024
    ds_read_b128 v[176:179], v64 offset:2048
    ds_read_b128 v[172:175], v64 offset:3072
    ds_read_b128 v[168:171], v64 offset:4096
    ds_read_b128 v[164:167], v64 offset:5120
    ds_read_b128 v[160:163], v64 offset:6144
    ds_read_b128 v[156:159], v64 offset:7168
    ds_read_b128 v[36:39], v64 offset:8192
    ds_read_b128 v[32:35], v64 offset:9216
    ds_read_b128 v[28:31], v64 offset:10240
    ds_read_b128 v[24:27], v64 offset:11264
    ds_read_b128 v[20:23], v64 offset:12288
    ds_read_b128 v[16:19], v64 offset:13312
    ds_read_b128 v[12:15], v64 offset:14336
    ds_read_b128 v[8:11], v64 offset:15360
    v_lshrrev_b32 v6, 1, v3
    s_lshl_b32 s24, s3, 1
    v_add_u32 v6, s24, v6
    v_lshl_add_u32 v6, v6, 5, v2
    v_mul_u32_u24 v6, 10240, v6
    v_and_b32 v65, 1, v3
    v_lshl_add_u32 v6, v65, 4, v6
    s_lshl_b32 s6, s2, 5
    s_lshl_b32 s7, s5, 5
    s_add_u32 s8, s6, 163840
    s_add_u32 s9, s7, 163840
    s_waitcnt lgkmcnt(8)
    v_mfma_f32_16x16x32_f16 v[216:219], v[96:99], v[184:187], 0
    v_mfma_f32_16x16x32_f16 v[220:223], v[104:107], v[184:187], 0
    v_mfma_f32_16x16x32_f16 v[224:227], v[96:99], v[168:171], 0
    v_mfma_f32_16x16x32_f16 v[228:231], v[104:107], v[168:171], 0
    v_mfma_f32_16x16x32_f16 v[216:219], v[128:131], v[176:179], v[216:219]
    v_mfma_f32_16x16x32_f16 v[220:223], v[96:99], v[176:179], v[220:223]
    v_mfma_f32_16x16x32_f16 v[224:227], v[128:131], v[160:163], v[224:227]
    v_mfma_f32_16x16x32_f16 v[228:231], v[96:99], v[160:163], v[228:231]
    v_mfma_f32_16x16x32_f16 v[216:219], v[100:103], v[180:183], v[216:219]
    v_mfma_f32_16x16x32_f16 v[220:223], v[108:111], v[180:183], v[220:223]
    v_mfma_f32_16x16x32_f16 v[224:227], v[100:103], v[164:167], v[224:227]
    v_mfma_f32_16x16x32_f16 v[228:231], v[108:111], v[164:167], v[228:231]
    v_mfma_f32_16x16x32_f16 v[216:219], v[132:135], v[172:175], v[216:219]
    v_mfma_f32_16x16x32_f16 v[220:223], v[100:103], v[172:175], v[220:223]
    v_mfma_f32_16x16x32_f16 v[224:227], v[132:135], v[156:159], v[224:227]
    v_mfma_f32_16x16x32_f16 v[228:231], v[100:103], v[156:159], v[228:231]
    s_waitcnt lgkmcnt(0)
    v_mfma_f32_16x16x32_f16 v[232:235], v[96:99], v[36:39], 0
    v_mfma_f32_16x16x32_f16 v[236:239], v[104:107], v[36:39], 0
    v_mfma_f32_16x16x32_f16 v[240:243], v[96:99], v[20:23], 0
    v_mfma_f32_16x16x32_f16 v[244:247], v[104:107], v[20:23], 0
    v_mfma_f32_16x16x32_f16 v[232:235], v[128:131], v[28:31], v[232:235]
    v_mfma_f32_16x16x32_f16 v[236:239], v[96:99], v[28:31], v[236:239]
    v_mfma_f32_16x16x32_f16 v[240:243], v[128:131], v[12:15], v[240:243]
    v_mfma_f32_16x16x32_f16 v[244:247], v[96:99], v[12:15], v[244:247]
    v_mfma_f32_16x16x32_f16 v[232:235], v[100:103], v[32:35], v[232:235]
    v_mfma_f32_16x16x32_f16 v[236:239], v[108:111], v[32:35], v[236:239]
    v_mfma_f32_16x16x32_f16 v[240:243], v[100:103], v[16:19], v[240:243]
    v_mfma_f32_16x16x32_f16 v[244:247], v[108:111], v[16:19], v[244:247]
    v_mfma_f32_16x16x32_f16 v[232:235], v[132:135], v[24:27], v[232:235]
    v_mfma_f32_16x16x32_f16 v[236:239], v[100:103], v[24:27], v[236:239]
    v_mfma_f32_16x16x32_f16 v[240:243], v[132:135], v[8:11], v[240:243]
    v_mfma_f32_16x16x32_f16 v[244:247], v[100:103], v[8:11], v[244:247]
    v_cvt_pk_f16_f32 v216, v216, v220
    v_cvt_pk_f16_f32 v217, v217, v221
    v_cvt_pk_f16_f32 v218, v218, v222
    v_cvt_pk_f16_f32 v219, v219, v223
    buffer_store_dwordx4 v[216:219], v6, s[20:23], s6 offen
    v_cvt_pk_f16_f32 v224, v224, v228
    v_cvt_pk_f16_f32 v225, v225, v229
    v_cvt_pk_f16_f32 v226, v226, v230
    v_cvt_pk_f16_f32 v227, v227, v231
    buffer_store_dwordx4 v[224:227], v6, s[20:23], s8 offen
    s_cmp_eq_u32 s2, s5
    s_nop 2
    s_cbranch_scc1 k2_kernel_end
    v_cvt_pk_f16_f32 v232, v232, -v236
    v_cvt_pk_f16_f32 v233, v233, -v237
    v_cvt_pk_f16_f32 v234, v234, -v238
    v_cvt_pk_f16_f32 v235, v235, -v239
    buffer_store_dwordx4 v[232:235], v6, s[20:23], s7 offen
    v_cvt_pk_f16_f32 v240, v240, -v244
    v_cvt_pk_f16_f32 v241, v241, -v245
    v_cvt_pk_f16_f32 v242, v242, -v246
    v_cvt_pk_f16_f32 v243, v243, -v247
    buffer_store_dwordx4 v[240:243], v6, s[20:23], s9 offen
    s_endpgm
    s_nop 2
k2_pack:
    s_load_dwordx2 s[4:5], s[0:1], 48
    s_load_dwordx2 s[8:9], s[0:1], 32
    s_load_dwordx2 s[12:13], s[0:1], 40
    v_lshrrev_b32 v1, 6, v0
    s_nop 0
    v_readfirstlane_b32 s20, v1
    v_and_b32 v1, 63, v0
    s_sub_u32 s3, s2, 161
    v_add_u32 v2, 0, v1
    v_mul_u32_u24 v3, 52429, v2
    v_lshrrev_b32 v3, 19, v3
    v_mul_u32_u24 v4, 10, v3
    v_sub_u32 v2, v2, v4
    v_lshrrev_b32 v4, 1, v3
    v_and_b32 v4, 4, v4
    v_xor_b32 v3, v3, v4
    v_mul_u32_u24 v3, 1280, v3
    v_lshl_add_u32 v5, v2, 4, v3
    v_add_u32 v2, 64, v1
    v_mul_u32_u24 v3, 52429, v2
    v_lshrrev_b32 v3, 19, v3
    v_mul_u32_u24 v4, 10, v3
    v_sub_u32 v2, v2, v4
    v_lshrrev_b32 v4, 1, v3
    v_and_b32 v4, 4, v4
    v_xor_b32 v3, v3, v4
    v_mul_u32_u24 v3, 1280, v3
    v_lshl_add_u32 v6, v2, 4, v3
    v_add_u32 v2, 128, v1
    v_mul_u32_u24 v3, 52429, v2
    v_lshrrev_b32 v3, 19, v3
    v_mul_u32_u24 v4, 10, v3
    v_sub_u32 v2, v2, v4
    v_lshrrev_b32 v4, 1, v3
    v_and_b32 v4, 4, v4
    v_xor_b32 v3, v3, v4
    v_mul_u32_u24 v3, 1280, v3
    v_lshl_add_u32 v7, v2, 4, v3
    v_add_u32 v2, 192, v1
    v_mul_u32_u24 v3, 52429, v2
    v_lshrrev_b32 v3, 19, v3
    v_mul_u32_u24 v4, 10, v3
    v_sub_u32 v2, v2, v4
    v_lshrrev_b32 v4, 1, v3
    v_and_b32 v4, 4, v4
    v_xor_b32 v3, v3, v4
    v_mul_u32_u24 v3, 1280, v3
    v_lshl_add_u32 v8, v2, 4, v3
    v_add_u32 v2, 256, v1
    v_mul_u32_u24 v3, 52429, v2
    v_lshrrev_b32 v3, 19, v3
    v_mul_u32_u24 v4, 10, v3
    v_sub_u32 v2, v2, v4
    v_lshrrev_b32 v4, 1, v3
    v_and_b32 v4, 4, v4
    v_xor_b32 v3, v3, v4
    v_mul_u32_u24 v3, 1280, v3
    v_lshl_add_u32 v9, v2, 4, v3
    s_lshl_b32 s21, s3, 2
    s_add_u32 s21, s21, s20
    s_and_b32 s22, s21, 7
    s_lshr_b32 s21, s21, 3
    s_mul_i32 s23, s21, 40960
    s_mul_i32 s28, s22, 160
    s_add_u32 s23, s23, s28
    s_mul_i32 s28, s22, 28
    s_lshr_b32 s29, s21, 1
    s_add_u32 s28, s28, s29
    s_mul_i32 s28, s28, 10240
    s_mov_b32 s35, s21
    s_and_b32 s21, s21, 1
    s_mul_i32 s30, s21, 3072
    s_add_u32 s30, s30, s28
    s_mul_i32 s31, s21, 3072
    s_add_u32 s31, s31, s28
    s_add_u32 s31, s31, 1024
    s_mul_i32 s32, s21, -3072
    s_add_u32 s32, s32, s28
    s_add_u32 s32, s32, 8192
    s_mul_i32 s33, s21, -3072
    s_add_u32 s33, s33, s28
    s_add_u32 s33, s33, 9216
    s_mul_i32 s34, s21, 5120
    s_add_u32 s34, s34, s28
    s_add_u32 s34, s34, 2048
    s_mul_i32 s20, s20, 5120
    v_lshrrev_b32 v12, 4, v1
    v_bfe_u32 v2, v1, 2, 2
    v_lshl_add_u32 v2, v12, 3, v2
    v_and_b32 v3, 1, v12
    v_lshl_add_u32 v4, v3, 2, v2
    v_xor_b32 v3, 1, v3
    v_lshl_add_u32 v2, v3, 2, v2
    v_and_b32 v3, 3, v1
    v_lshlrev_b32 v3, 3, v3
    v_add_u32 v3, s20, v3
    v_mul_u32_u24 v4, 160, v4
    v_mul_u32_u24 v2, 160, v2
    v_add_u32 v10, v4, v3
    v_add_u32 v11, v2, v3
    v_lshlrev_b32 v13, 4, v1
    s_lshl_b32 s21, s3, 12
    v_lshlrev_b32 v12, 4, v0
    v_add_u32 v12, s21, v12
    s_waitcnt lgkmcnt(0)
    s_add_u32 s24, s16, 0x7b0000
    s_addc_u32 s25, s17, 0
    s_mov_b32 s26, 0x800
    s_mov_b32 s27, 0x00020000
    s_mov_b32 s6, 0x21c000
    s_mov_b32 s7, 0x00020000
    s_add_u32 m0, s20, 0
    s_nop 0
    buffer_load_dwordx4 v5, s[4:7], s23 offen lds
    s_add_u32 m0, s20, 1024
    s_nop 0
    buffer_load_dwordx4 v6, s[4:7], s23 offen lds
    s_add_u32 m0, s20, 2048
    s_nop 0
    buffer_load_dwordx4 v7, s[4:7], s23 offen lds
    s_add_u32 m0, s20, 3072
    s_nop 0
    buffer_load_dwordx4 v8, s[4:7], s23 offen lds
    s_add_u32 m0, s20, 4096
    s_nop 0
    buffer_load_dwordx4 v9, s[4:7], s23 offen lds
    s_cmp_lg_u32 s2, 255
    s_nop 0
    s_cbranch_scc1 k2_nozero
    v_lshlrev_b32 v14, 3, v0
    v_mov_b32 v16, 0
    v_mov_b32 v17, 0
    buffer_store_dwordx2 v[16:17], v14, s[24:27], 0 offen
    s_waitcnt vmcnt(0)
    s_nop 2
k2_nozero:
    s_add_u32 s16, s16, 0x1400000
    s_addc_u32 s17, s17, 0
    s_mov_b32 s18, 0x230000
    s_mov_b32 s19, 0x00020000
    s_mov_b32 s10, 0x21c000
    s_mov_b32 s11, 0x00020000
    s_mov_b32 s14, 0x21c000
    s_mov_b32 s15, 0x00020000
    s_mov_b32 s22, 0
    buffer_load_dwordx4 v[40:43], v12, s[8:11], s22 offen
    buffer_load_dwordx4 v[44:47], v12, s[12:15], s22 offen
    s_mov_b32 s22, 442368
    buffer_load_dwordx4 v[48:51], v12, s[8:11], s22 offen
    buffer_load_dwordx4 v[52:55], v12, s[12:15], s22 offen
    s_mov_b32 s22, 884736
    buffer_load_dwordx4 v[56:59], v12, s[8:11], s22 offen
    buffer_load_dwordx4 v[60:63], v12, s[12:15], s22 offen
    s_mov_b32 s22, 1327104
    buffer_load_dwordx4 v[64:67], v12, s[8:11], s22 offen
    buffer_load_dwordx4 v[68:71], v12, s[12:15], s22 offen
    s_mov_b32 s22, 1769472
    buffer_load_dwordx4 v[72:75], v12, s[8:11], s22 offen
    buffer_load_dwordx4 v[76:79], v12, s[12:15], s22 offen
    s_waitcnt vmcnt(10)
    ds_read_b64_tr_b16 v[20:21], v10 offset:0
    ds_read_b64_tr_b16 v[22:23], v11 offset:0
    ds_read_b64_tr_b16 v[24:25], v10 offset:32
    ds_read_b64_tr_b16 v[26:27], v11 offset:32
    ds_read_b64_tr_b16 v[28:29], v10 offset:64
    ds_read_b64_tr_b16 v[30:31], v11 offset:64
    ds_read_b64_tr_b16 v[32:33], v10 offset:96
    ds_read_b64_tr_b16 v[34:35], v11 offset:96
    ds_read_b64_tr_b16 v[36:37], v10 offset:128
    ds_read_b64_tr_b16 v[38:39], v11 offset:128
    s_cmp_lt_u32 s35, 54
    s_nop 0
    s_cbranch_scc1 k2_nopad
    s_waitcnt lgkmcnt(0)
    v_mov_b32 v20, 0
    v_mov_b32 v21, 0
    v_mov_b32 v22, 0
    v_mov_b32 v23, 0
    v_mov_b32 v24, 0
    v_mov_b32 v25, 0
    v_mov_b32 v26, 0
    v_mov_b32 v27, 0
    v_mov_b32 v28, 0
    v_mov_b32 v29, 0
    v_mov_b32 v30, 0
    v_mov_b32 v31, 0
    v_mov_b32 v32, 0
    v_mov_b32 v33, 0
    v_mov_b32 v34, 0
    v_mov_b32 v35, 0
    v_mov_b32 v36, 0
    v_mov_b32 v37, 0
    v_mov_b32 v38, 0
    v_mov_b32 v39, 0
    s_nop 4
k2_nopad:
    s_waitcnt lgkmcnt(8)
    buffer_store_dwordx4 v[20:23], v13, s[16:19], s30 offen
    s_waitcnt lgkmcnt(6)
    buffer_store_dwordx4 v[24:27], v13, s[16:19], s31 offen
    s_waitcnt lgkmcnt(4)
    buffer_store_dwordx4 v[28:31], v13, s[16:19], s32 offen
    s_waitcnt lgkmcnt(2)
    buffer_store_dwordx4 v[32:35], v13, s[16:19], s33 offen
    s_waitcnt lgkmcnt(0)
    buffer_store_dwordx4 v[36:39], v13, s[16:19], s34 offen
    s_waitcnt vmcnt(0)
    s_nop 0
k2_kernel_end:
    s_endpgm
.globl k3_kernel
.p2align 8
.type k3_kernel,@function
k3_kernel:
    s_cmp_ge_u32 s2, 256
    s_nop 0
    s_cbranch_scc1 k3_kernel_end
    s_getreg_b32 s52, hwreg(HW_REG_XCC_ID)
    s_and_b32 s52, s52, 7
    s_lshr_b32 s53, s2, 3
    s_mov_b32 s54, 0
    s_lshl_b32 s55, s52, 8
    s_getpc_b64 s[14:15]
pc_cw_2308:
    v_lshlrev_b32 v222, 6, v0
    s_sub_u32 s14, s14, pc_cw_2308-k3_kernel
    s_subb_u32 s15, s15, 0
    v_min_u32 v222, k3_kernel_end-k3_kernel, v222
    global_load_dword v223, v222, s[14:15]
    s_nop 3
k3_restart:
    s_load_dwordx2 s[40:41], s[0:1], 32
    s_load_dwordx2 s[44:45], s[0:1], 40
    s_load_dwordx2 s[48:49], s[0:1], 72
    s_lshl_b32 s2, s52, 5
    s_add_u32 s2, s2, s53
    s_load_dwordx2 s[4:5], s[0:1], 0
    s_load_dwordx2 s[16:17], s[0:1], 72
    v_lshrrev_b32 v1, 6, v0
    s_nop 0
    v_readfirstlane_b32 s3, v1
    v_and_b32 v1, 63, v0
    v_and_b32 v2, 15, v0
    v_bfe_u32 v3, v0, 4, 2
    v_mul_u32_u24 v4, 320, v3
    v_lshl_add_u32 v4, v2, 2, v4
    s_lshr_b32 s22, s2, 5
    s_and_b32 s23, s2, 31
    s_lshl_b32 s20, s22, 3
    s_add_u32 s20, s20, s3
    s_lshl_b32 s20, s20, 5
    s_add_u32 s20, s20, s23
    s_mul_i32 s20, s20, 1280
    s_lshl_b32 s21, s23, 8
    s_lshl_b32 s22, s22, 5
    s_add_u32 s21, s21, s22
    s_mul_i32 s24, s3, 1280
    v_lshlrev_b32 v5, 4, v1
    v_add_u32 v6, 8192, v5
    s_getpc_b64 s[14:15]
pc_ctab3_2345:
    s_sub_u32 s14, s14, pc_ctab3_2345-ctab3-4096
    s_subb_u32 s15, s15, 0
    s_lshl_b32 s25, s3, 3
    v_lshrrev_b32 v205, 3, v1
    v_add_u32 v205, s25, v205
    v_mul_u32_u24 v205, 3456, v205
    v_lshrrev_b32 v206, 2, v1
    v_and_b32 v206, 4, v206
    v_xor_b32 v206, v206, v1
    v_and_b32 v206, 7, v206
    v_lshl_add_u32 v204, v206, 4, v205
    s_min_u32 s25, s53, 26
    s_lshl_b32 s26, s25, 7
    v_add_u32 v204, s26, v204
    s_lshl_b32 s27, s3, 10
    s_mul_i32 s26, s25, 205
    s_lshr_b32 s26, s26, 11
    s_mul_i32 s26, s26, 10
    s_sub_u32 s50, s25, s26
    s_mov_b32 s51, s50
    s_lshl_b32 s25, 1, s53
    v_mov_b32 v207, s25
    s_waitcnt lgkmcnt(0)
    s_add_u32 s56, s16, 0x7b0000
    s_addc_u32 s57, s17, 0
    s_mov_b32 s58, 0x800
    s_mov_b32 s59, 0x00020000
    s_or_b32 s25, s54, s3
    s_cmp_lg_u32 s25, 0
    s_nop 0
    s_cbranch_scc1 k3_noclaim
    s_mov_b64 exec, 1
    buffer_atomic_or v207, off, s[56:59], s55 sc0
    s_mov_b64 exec, -1
    s_nop 0
k3_noclaim:
    s_mov_b32 s42, 0x21c000
    s_mov_b32 s43, 0x00020000
    s_mov_b32 s46, 0x21c000
    s_mov_b32 s47, 0x00020000
    s_add_u32 s28, s16, 0x800000
    s_addc_u32 s29, s17, 0
    s_mov_b32 s30, 0x280000
    s_mov_b32 s31, 0x00020000
    s_add_u32 s32, s16, 0x7a0000
    s_addc_u32 s33, s17, 0
    s_mov_b32 s34, 0x400
    s_mov_b32 s35, 0x00020000
    s_add_u32 s36, s16, 0xa80000
    s_addc_u32 s37, s17, 0
    s_mov_b32 s38, 0x280000
    s_mov_b32 s39, 0x00020000
    s_mov_b32 s6, 0x280000
    s_mov_b32 s7, 0x00020000
    s_add_u32 s16, s16, 0x280000
    s_addc_u32 s17, s17, 0
    s_mov_b32 s18, 0x280000
    s_mov_b32 s19, 0x00020000
    s_cmp_ge_u32 s3, 5
    s_nop 0
    s_cbranch_scc1 k3_nold
    v_lshlrev_b32 v16, 5, v0
    s_mul_i32 s21, s2, 10240
    buffer_load_dwordx4 v[8:11], v16, s[16:19], s21 offen
    buffer_load_dwordx4 v[12:15], v16, s[16:19], s21 offen offset:16
    s_nop 1
k3_nold:
    v_lshlrev_b32 v24, 4, v1
    buffer_load_dwordx4 v[20:23], v24, s[32:35], 0 offen
    global_load_dwordx4 v[28:31], v5, s[14:15] offset:-4096
    global_load_dwordx4 v[32:35], v5, s[14:15] offset:-3072
    global_load_dwordx4 v[36:39], v5, s[14:15] offset:-2048
    global_load_dwordx4 v[40:43], v5, s[14:15] offset:-1024
    global_load_dwordx4 v[44:47], v5, s[14:15] offset:0
    global_load_dwordx4 v[48:51], v5, s[14:15] offset:1024
    global_load_dwordx4 v[52:55], v5, s[14:15] offset:2048
    global_load_dwordx4 v[56:59], v5, s[14:15] offset:3072
    global_load_dwordx4 v[64:67], v6, s[14:15] offset:-4096
    global_load_dwordx4 v[68:71], v6, s[14:15] offset:-3072
    buffer_load_dword v76, v4, s[4:7], s20 offen offset:0
    buffer_load_dword v77, v4, s[4:7], s20 offen offset:64
    buffer_load_dword v78, v4, s[4:7], s20 offen offset:128
    buffer_load_dword v79, v4, s[4:7], s20 offen offset:192
    buffer_load_dword v80, v4, s[4:7], s20 offen offset:256
    s_waitcnt vmcnt(15)
    s_cmp_lg_u32 s3, 0
    s_nop 0
    s_cbranch_scc1 k3_cl_skip
    s_mov_b32 s60, s53
    s_cmp_lg_u32 s54, 0
    s_nop 0
    s_cbranch_scc1 k3_cl_done
    s_nop 0
k3_cl_loop:
    v_readfirstlane_b32 s61, v207
    s_bitcmp0_b32 s61, s60
    s_nop 3
    s_cbranch_scc1 k3_cl_done
    s_not_b32 s61, s61
    s_ff1_i32_b32 s60, s61
    s_and_b32 s60, s60, 255
    s_cmp_ge_u32 s60, 32
    s_nop 0
    s_cbranch_scc1 k3_cl_done
    s_lshl_b32 s61, 1, s60
    v_mov_b32 v207, s61
    s_mov_b64 exec, 1
    buffer_atomic_or v207, off, s[56:59], s55 sc0
    s_waitcnt vmcnt(0)
    s_mov_b64 exec, -1
    s_nop 0
    s_branch k3_cl_loop
    s_nop 0
k3_cl_done:
    v_mov_b32 v205, s60
    v_mov_b32 v206, 0
    ds_write_b32 v206, v205 offset:10496
    s_nop 3
k3_cl_skip:
    v_max_u32 v20, v20, v21
    v_max3_u32 v18, v20, v22, v23
    s_nop 1
    v_max_u32_dpp v18, v18, v18 quad_perm:[1,0,3,2] row_mask:0xf bank_mask:0xf
    s_nop 1
    v_max_u32_dpp v18, v18, v18 quad_perm:[2,3,0,1] row_mask:0xf bank_mask:0xf
    s_nop 1
    v_max_u32_dpp v18, v18, v18 row_half_mirror row_mask:0xf bank_mask:0xf
    s_nop 1
    v_max_u32_dpp v18, v18, v18 row_mirror row_mask:0xf bank_mask:0xf
    v_mov_b32 v24, v18
    s_nop 1
    v_permlane16_swap_b32 v18, v24
    v_max_u32 v18, v18, v24
    v_mov_b32 v24, v18
    s_nop 1
    v_permlane32_swap_b32 v18, v24
    v_max_u32 v18, v18, v24
    v_lshrrev_b32 v18, 7, v18
    v_max_u32 v18, 8, v18
    v_min_u32 v18, 0xfa, v18
    v_lshlrev_b32 v18, 23, v18
    v_mul_f32 v18, 0x3dcccccd, v18
    s_cmp_ge_u32 s3, 5
    s_nop 3
    s_cbranch_scc1 k3_nowr
    v_lshlrev_b32 v17, 2, v0
    ds_write2st64_b32 v17, v8, v9 offset0:0 offset1:5
    ds_write2st64_b32 v17, v10, v11 offset0:10 offset1:15
    ds_write2st64_b32 v17, v12, v13 offset0:20 offset1:25
    ds_write2st64_b32 v17, v14, v15 offset0:30 offset1:35
    s_nop 0
k3_nowr:
    s_waitcnt lgkmcnt(0)
    s_barrier
    v_add_u32 v17, s24, v4
    v_and_b32 v82, 3, v2
    v_mul_u32_u24 v16, 320, v3
    v_lshl_add_u32 v16, v82, 2, v16
    v_add_u32 v16, s24, v16
    ds_read2_b32 v[92:93], v17 offset0:0 offset1:20
    ds_read2_b32 v[94:95], v17 offset0:40 offset1:60
    ds_read2_b32 v[96:97], v16 offset0:16 offset1:36
    ds_read2_b32 v[98:99], v16 offset0:56 offset1:76
    v_mov_b32 v206, 0
    ds_read_b32 v205, v206 offset:10496
    s_waitcnt lgkmcnt(0)
    v_readfirstlane_b32 s60, v205
    s_nop 0
    s_cmp_eq_u32 s60, s53
    s_nop 2
    s_cbranch_scc1 k3_ok
    s_waitcnt vmcnt(0)
    s_barrier
    s_mov_b32 s53, s60
    s_mov_b32 s54, 1
    s_cmp_ge_u32 s53, 32
    s_nop 0
    s_cbranch_scc1 k3_kernel_end
    s_nop 0
    s_branch k3_restart
    s_nop 0
k3_ok:
    s_mul_i32 s63, s50, 221184
    s_add_u32 s50, s50, 1
    s_cmp_eq_u32 s50, 10
    s_cselect_b32 s50, 0, s50
    s_add_u32 m0, s27, 32768
    s_nop 0
    buffer_load_dwordx4 v204, s[40:43], s63 offen lds
    s_add_u32 m0, s27, 40960
    s_nop 0
    buffer_load_dwordx4 v204, s[44:47], s63 offen lds
    s_waitcnt vmcnt(7)
    v_mfma_f32_16x16x32_f16 v[100:103], v[92:95], v[28:31], 0
    v_mfma_f32_16x16x32_f16 v[104:107], v[92:95], v[32:35], 0
    v_mfma_f32_16x16x32_f16 v[108:111], v[96:99], v[28:31], 0
    v_mfma_f32_16x16x32_f16 v[112:115], v[96:99], v[32:35], 0
    v_xor_b32 v60, 0x80008000, v56
    v_xor_b32 v61, 0x80008000, v57
    v_xor_b32 v62, 0x80008000, v58
    v_xor_b32 v63, 0x80008000, v59
    v_xor_b32 v72, 0x80008000, v68
    v_xor_b32 v73, 0x80008000, v69
    v_xor_b32 v74, 0x80008000, v70
    v_xor_b32 v75, 0x80008000, v71
    v_mul_f32 v124, v100, v36
    v_mul_f32 v128, v104, v36
    v_fma_f32 v124, -v104, v44, v124
    v_fmac_f32 v128, v100, v44
    v_mul_f32 v125, v101, v37
    v_mul_f32 v129, v105, v37
    v_fma_f32 v125, -v105, v45, v125
    v_fmac_f32 v129, v101, v45
    v_mul_f32 v126, v102, v38
    v_mul_f32 v130, v106, v38
    v_fma_f32 v126, -v106, v46, v126
    v_fmac_f32 v130, v102, v46
    v_mul_f32 v127, v103, v39
    v_mul_f32 v131, v107, v39
    v_fma_f32 v127, -v107, v47, v127
    v_fmac_f32 v131, v103, v47
    v_cvt_pk_f16_f32 v116, v124, v125
    v_cvt_pk_f16_f32 v117, v126, v127
    v_cvt_pk_f16_f32 v120, v128, v129
    v_cvt_pk_f16_f32 v121, v130, v131
    v_mul_f32 v124, v108, v40
    v_mul_f32 v128, v112, v40
    v_fma_f32 v124, -v112, v48, v124
    v_fmac_f32 v128, v108, v48
    v_mul_f32 v125, v109, v41
    v_mul_f32 v129, v113, v41
    v_fma_f32 v125, -v113, v49, v125
    v_fmac_f32 v129, v109, v49
    v_mul_f32 v126, v110, v42
    v_mul_f32 v130, v114, v42
    v_fma_f32 v126, -v114, v50, v126
    v_fmac_f32 v130, v110, v50
    v_mul_f32 v127, v111, v43
    v_mul_f32 v131, v115, v43
    v_fma_f32 v127, -v115, v51, v127
    v_fmac_f32 v131, v111, v51
    v_cvt_pk_f16_f32 v118, v124, v125
    v_cvt_pk_f16_f32 v119, v126, v127
    v_cvt_pk_f16_f32 v122, v128, v129
    v_cvt_pk_f16_f32 v123, v130, v131
    v_mfma_f32_16x16x32_f16 v[100:103], v[52:55], v[116:119], 0
    v_mfma_f32_16x16x32_f16 v[104:107], v[56:59], v[116:119], 0
    v_mfma_f32_16x16x32_f16 v[108:111], v[64:67], v[116:119], 0
    v_mfma_f32_16x16x32_f16 v[112:115], v[68:71], v[116:119], 0
    v_mfma_f32_16x16x32_f16 v[100:103], v[60:63], v[120:123], v[100:103]
    v_mfma_f32_16x16x32_f16 v[104:107], v[52:55], v[120:123], v[104:107]
    v_mfma_f32_16x16x32_f16 v[108:111], v[72:75], v[120:123], v[108:111]
    v_mfma_f32_16x16x32_f16 v[112:115], v[64:67], v[120:123], v[112:115]
    v_add_u32 v84, 0, v4
    v_lshrrev_b32 v85, 7, v84
    v_and_b32 v84, 127, v84
    v_lshl_add_u32 v160, v85, 15, v84
    v_add_u32 v84, 64, v4
    v_lshrrev_b32 v85, 7, v84
    v_and_b32 v84, 127, v84
    v_lshl_add_u32 v161, v85, 15, v84
    v_add_u32 v84, 128, v4
    v_lshrrev_b32 v85, 7, v84
    v_and_b32 v84, 127, v84
    v_lshl_add_u32 v162, v85, 15, v84
    v_add_u32 v84, 192, v4
    v_lshrrev_b32 v85, 7, v84
    v_and_b32 v84, 127, v84
    v_lshl_add_u32 v163, v85, 15, v84
    v_add_u32 v84, 256, v4
    v_lshrrev_b32 v85, 7, v84
    v_and_b32 v84, 127, v84
    v_lshl_add_u32 v164, v85, 15, v84
    s_lshl_b32 s21, s3, 5
    s_add_u32 s21, s21, s53
    s_lshl_b32 s21, s21, 7
    s_mul_i32 s22, s52, 327680
    s_add_u32 s21, s21, s22
    s_waitcnt vmcnt(2)
    v_mul_f32 v84, v100, v18
    v_mul_f32 v85, v104, v18
    v_cvt_pk_bf16_f32 v86, v84, v85
    v_lshlrev_b32 v84, 16, v86
    v_and_b32 v85, 0xffff0000, v86
    v_lshlrev_b32 v86, 16, v76
    v_and_b32 v87, 0xffff0000, v76
    v_add_f32 v84, v84, v86
    v_add_f32 v85, v85, v87
    v_cvt_pk_bf16_f32 v144, v84, v85
    v_lshlrev_b32 v132, 16, v144
    v_and_b32 v133, 0xffff0000, v144
    buffer_store_dword v144, v4, s[28:31], s20 offen offset:0 sc1
    v_mul_f32 v84, v101, v18
    v_mul_f32 v85, v105, v18
    v_cvt_pk_bf16_f32 v86, v84, v85
    v_lshlrev_b32 v84, 16, v86
    v_and_b32 v85, 0xffff0000, v86
    v_lshlrev_b32 v86, 16, v77
    v_and_b32 v87, 0xffff0000, v77
    v_add_f32 v84, v84, v86
    v_add_f32 v85, v85, v87
    v_cvt_pk_bf16_f32 v145, v84, v85
    v_lshlrev_b32 v134, 16, v145
    v_and_b32 v135, 0xffff0000, v145
    buffer_store_dword v145, v4, s[28:31], s20 offen offset:64 sc1
    v_mul_f32 v84, v102, v18
    v_mul_f32 v85, v106, v18
    v_cvt_pk_bf16_f32 v86, v84, v85
    v_lshlrev_b32 v84, 16, v86
    v_and_b32 v85, 0xffff0000, v86
    v_lshlrev_b32 v86, 16, v78
    v_and_b32 v87, 0xffff0000, v78
    v_add_f32 v84, v84, v86
    v_add_f32 v85, v85, v87
    v_cvt_pk_bf16_f32 v146, v84, v85
    v_lshlrev_b32 v136, 16, v146
    v_and_b32 v137, 0xffff0000, v146
    buffer_store_dword v146, v4, s[28:31], s20 offen offset:128 sc1
    v_mul_f32 v84, v103, v18
    v_mul_f32 v85, v107, v18
    v_cvt_pk_bf16_f32 v86, v84, v85
    v_lshlrev_b32 v84, 16, v86
    v_and_b32 v85, 0xffff0000, v86
    v_lshlrev_b32 v86, 16, v79
    v_and_b32 v87, 0xffff0000, v79
    v_add_f32 v84, v84, v86
    v_add_f32 v85, v85, v87
    v_cvt_pk_bf16_f32 v147, v84, v85
    v_lshlrev_b32 v138, 16, v147
    v_and_b32 v139, 0xffff0000, v147
    buffer_store_dword v147, v4, s[28:31], s20 offen offset:192 sc1
    v_mul_f32 v84, v108, v18
    v_mul_f32 v85, v112, v18
    v_cvt_pk_bf16_f32 v86, v84, v85
    v_lshlrev_b32 v84, 16, v86
    v_and_b32 v85, 0xffff0000, v86
    v_lshlrev_b32 v86, 16, v80
    v_and_b32 v87, 0xffff0000, v80
    v_add_f32 v84, v84, v86
    v_add_f32 v85, v85, v87
    v_cvt_pk_bf16_f32 v148, v84, v85
    v_lshlrev_b32 v140, 16, v148
    v_and_b32 v141, 0xffff0000, v148
    buffer_store_dword v148, v4, s[28:31], s20 offen offset:256 sc1
    v_add_f32 v165, v132, v133
    v_add_f32 v165, v165, v134
    v_add_f32 v165, v165, v135
    v_add_f32 v165, v165, v136
    v_add_f32 v165, v165, v137
    v_add_f32 v165, v165, v138
    v_add_f32 v165, v165, v139
    v_add_f32 v165, v165, v140
    v_add_f32 v165, v165, v141
    s_nop 1
    v_add_f32_dpp v165, v165, v165 quad_perm:[1,0,3,2] row_mask:0xf bank_mask:0xf
    s_nop 1
    v_add_f32_dpp v165, v165, v165 quad_perm:[2,3,0,1] row_mask:0xf bank_mask:0xf
    s_nop 1
    v_add_f32_dpp v165, v165, v165 row_half_mirror row_mask:0xf bank_mask:0xf
    s_nop 1
    v_add_f32_dpp v165, v165, v165 row_mirror row_mask:0xf bank_mask:0xf
    v_mov_b32 v166, v165
    s_nop 1
    v_permlane16_swap_b32 v165, v166
    v_add_f32 v165, v165, v166
    v_mov_b32 v166, v165
    s_nop 1
    v_permlane32_swap_b32 v165, v166
    v_add_f32 v165, v165, v166
    v_mul_f32 v167, 0x3acccccd, v165
    v_sub_f32 v166, v132, v167
    v_mul_f32 v165, v166, v166
    v_sub_f32 v166, v133, v167
    v_fmac_f32 v165, v166, v166
    v_sub_f32 v166, v134, v167
    v_fmac_f32 v165, v166, v166
    v_sub_f32 v166, v135, v167
    v_fmac_f32 v165, v166, v166
    v_sub_f32 v166, v136, v167
    v_fmac_f32 v165, v166, v166
    v_sub_f32 v166, v137, v167
    v_fmac_f32 v165, v166, v166
    v_sub_f32 v166, v138, v167
    v_fmac_f32 v165, v166, v166
    v_sub_f32 v166, v139, v167
    v_fmac_f32 v165, v166, v166
    v_sub_f32 v166, v140, v167
    v_fmac_f32 v165, v166, v166
    v_sub_f32 v166, v141, v167
    v_fmac_f32 v165, v166, v166
    s_nop 1
    v_add_f32_dpp v165, v165, v165 quad_perm:[1,0,3,2] row_mask:0xf bank_mask:0xf
    s_nop 1
    v_add_f32_dpp v165, v165, v165 quad_perm:[2,3,0,1] row_mask:0xf bank_mask:0xf
    s_nop 1
    v_add_f32_dpp v165, v165, v165 row_half_mirror row_mask:0xf bank_mask:0xf
    s_nop 1
    v_add_f32_dpp v165, v165, v165 row_mirror row_mask:0xf bank_mask:0xf
    v_mov_b32 v166, v165
    s_nop 1
    v_permlane16_swap_b32 v165, v166
    v_add_f32 v165, v165, v166
    v_mov_b32 v166, v165
    s_nop 1
    v_permlane32_swap_b32 v165, v166
    v_add_f32 v165, v165, v166
    v_mul_f32 v165, 0x3acccccd, v165
    v_cvt_pk_bf16_f32 v165, v165, v165
    v_lshlrev_b32 v165, 16, v165
    v_cvt_pk_bf16_f32 v167, v167, v167
    v_lshlrev_b32 v167, 16, v167
    v_add_f32 v165, 0x3727c5ac, v165
    v_cvt_pk_bf16_f32 v165, v165, v165
    v_lshlrev_b32 v165, 16, v165
    v_sqrt_f32 v165, v165
    s_nop 0
    v_cvt_pk_bf16_f32 v165, v165, v165
    v_lshlrev_b32 v165, 16, v165
    v_rcp_f32 v166, v165
    v_sub_f32 v132, v132, v167
    v_sub_f32 v133, v133, v167
    v_cvt_pk_bf16_f32 v133, v132, v133
    v_lshlrev_b32 v132, 16, v133
    v_and_b32 v133, 0xffff0000, v133
    v_mul_f32 v168, v132, v166
    v_mul_f32 v170, v133, v166
    v_fma_f32 v169, -v168, v165, v132
    v_fma_f32 v171, -v170, v165, v133
    v_fmac_f32 v168, v169, v166
    v_fmac_f32 v170, v171, v166
    v_cvt_pk_bf16_f32 v152, v168, v170
    v_sub_f32 v134, v134, v167
    v_sub_f32 v135, v135, v167
    v_cvt_pk_bf16_f32 v135, v134, v135
    v_lshlrev_b32 v134, 16, v135
    v_and_b32 v135, 0xffff0000, v135
    v_mul_f32 v168, v134, v166
    v_mul_f32 v170, v135, v166
    v_fma_f32 v169, -v168, v165, v134
    v_fma_f32 v171, -v170, v165, v135
    v_fmac_f32 v168, v169, v166
    v_fmac_f32 v170, v171, v166
    v_cvt_pk_bf16_f32 v153, v168, v170
    v_sub_f32 v136, v136, v167
    v_sub_f32 v137, v137, v167
    v_cvt_pk_bf16_f32 v137, v136, v137
    v_lshlrev_b32 v136, 16, v137
    v_and_b32 v137, 0xffff0000, v137
    v_mul_f32 v168, v136, v166
    v_mul_f32 v170, v137, v166
    v_fma_f32 v169, -v168, v165, v136
    v_fma_f32 v171, -v170, v165, v137
    v_fmac_f32 v168, v169, v166
    v_fmac_f32 v170, v171, v166
    v_cvt_pk_bf16_f32 v154, v168, v170
    v_sub_f32 v138, v138, v167
    v_sub_f32 v139, v139, v167
    v_cvt_pk_bf16_f32 v139, v138, v139
    v_lshlrev_b32 v138, 16, v139
    v_and_b32 v139, 0xffff0000, v139
    v_mul_f32 v168, v138, v166
    v_mul_f32 v170, v139, v166
    v_fma_f32 v169, -v168, v165, v138
    v_fma_f32 v171, -v170, v165, v139
    v_fmac_f32 v168, v169, v166
    v_fmac_f32 v170, v171, v166
    v_cvt_pk_bf16_f32 v155, v168, v170
    v_sub_f32 v140, v140, v167
    v_sub_f32 v141, v141, v167
    v_cvt_pk_bf16_f32 v141, v140, v141
    v_lshlrev_b32 v140, 16, v141
    v_and_b32 v141, 0xffff0000, v141
    v_mul_f32 v168, v140, v166
    v_mul_f32 v170, v141, v166
    v_fma_f32 v169, -v168, v165, v140
    v_fma_f32 v171, -v170, v165, v141
    v_fmac_f32 v168, v169, v166
    v_fmac_f32 v170, v171, v166
    v_cvt_pk_bf16_f32 v156, v168, v170
    buffer_store_dword v152, v160, s[36:39], s21 offen sc1
    buffer_store_dword v153, v161, s[36:39], s21 offen sc1
    buffer_store_dword v154, v162, s[36:39], s21 offen sc1
    buffer_store_dword v155, v163, s[36:39], s21 offen sc1
    buffer_store_dword v156, v164, s[36:39], s21 offen sc1
    s_mul_i32 s63, s50, 221184
    s_add_u32 s50, s50, 1
    s_cmp_eq_u32 s50, 10
    s_cselect_b32 s50, 0, s50
    s_add_u32 m0, s27, 81920
    s_nop 0
    buffer_load_dwordx4 v204, s[40:43], s63 offen lds
    s_add_u32 m0, s27, 90112
    s_nop 0
    buffer_load_dwordx4 v204, s[44:47], s63 offen lds
    v_lshrrev_b32 v1, 6, v0
    s_nop 0
    v_readfirstlane_b32 s3, v1
    v_and_b32 v1, 63, v0
    s_and_b32 s4, s2, 7
    s_lshr_b32 s5, s2, 3
    s_mov_b32 s4, s52
    s_mov_b32 s5, s53
    s_mov_b32 s32, s51
    s_lshr_b32 s6, s3, 1
    s_and_b32 s7, s3, 1
    s_mul_i32 s24, s4, 2560
    s_lshl_b32 s25, s3, 5
    s_add_u32 s24, s24, s25
    v_lshrrev_b32 v2, 3, v1
    v_add_u32 v3, s24, v2
    v_mul_u32_u24 v3, 128, v3
    v_lshrrev_b32 v4, 4, v1
    v_xor_b32 v4, v4, v1
    v_and_b32 v4, 7, v4
    v_mov_b32 v8, v4
    v_lshl_add_u32 v8, v8, 4, v3
    v_xor_b32 v9, 4, v4
    v_lshl_add_u32 v9, v9, 4, v3
    v_add_u32 v9, 1024, v9
    v_mov_b32 v10, v4
    v_lshl_add_u32 v10, v10, 4, v3
    v_add_u32 v10, 2048, v10
    v_xor_b32 v11, 4, v4
    v_lshl_add_u32 v11, v11, 4, v3
    v_add_u32 v11, 3072, v11
    v_mov_b32 v6, v204
    s_lshl_b32 s26, s3, 12
    s_lshl_b32 s27, s3, 10
    s_add_u32 s20, s48, 0xd00000
    s_addc_u32 s21, s49, 0
    s_mov_b32 s22, 0x6c0000
    s_mov_b32 s23, 0x00020000
    s_add_u32 s16, s48, 0xa80000
    s_addc_u32 s17, s49, 0
    s_mov_b32 s18, 0x280000
    s_mov_b32 s19, 0x00020000
    s_add_u32 s8, s48, 0x1400000
    s_addc_u32 s9, s49, 0
    s_mov_b32 s10, 0x230000
    s_mov_b32 s11, 0x00020000
    v_lshlrev_b32 v5, 4, v1
    s_lshr_b32 s14, s53, 2
    s_and_b32 s12, s53, 3
    s_lshl_b32 s12, s12, 1
    s_add_u32 s12, s12, s14
    s_cmp_ge_u32 s12, 7
    s_cselect_b32 s30, 7, 0
    s_sub_u32 s12, s12, s30
    s_lshl_b32 s14, s14, 2
    s_and_b32 s30, s3, 3
    s_add_u32 s14, s14, s30
    s_mul_i32 s15, s14, 71680
    s_lshr_b32 s31, s3, 2
    s_mul_i32 s31, s31, 5120
    s_add_u32 s15, s15, s31
    s_add_u32 s14, s15, 71680
    s_mul_i32 s12, s12, 10240
    s_add_u32 s12, s12, s15
    s_add_u32 s13, s12, 4096
    s_mul_i32 s30, s3, 5120
    s_waitcnt vmcnt(2)
    s_barrier
    s_cmp_lg_u32 s3, 0
    s_nop 0
    s_cbranch_scc1 k4_aA_na
    s_mov_b64 exec, 1
    v_mov_b32 v205, 1
    buffer_atomic_add v205, off, s[56:59], s55 offset:64
    s_mov_b64 exec, -1
    s_nop 2
k4_aA_na:
    s_cmp_ge_u32 s53, 27
    s_nop 0
    s_cbranch_scc1 k4_idle
    v_and_b32 v2, 31, v1
    s_lshl_b32 s25, s6, 6
    v_add_u32 v2, s25, v2
    v_lshlrev_b32 v2, 7, v2
    v_lshrrev_b32 v3, 5, v1
    v_bfe_u32 v4, v1, 1, 3
    v_xor_b32 v4, v4, v3
    v_xor_b32 v12, 0, v4
    v_lshl_add_u32 v12, v12, 4, v2
    v_add_u32 v16, 98304, v12
    v_xor_b32 v13, 2, v4
    v_lshl_add_u32 v13, v13, 4, v2
    v_add_u32 v17, 98304, v13
    v_xor_b32 v14, 4, v4
    v_lshl_add_u32 v14, v14, 4, v2
    v_add_u32 v18, 98304, v14
    v_xor_b32 v15, 6, v4
    v_lshl_add_u32 v15, v15, 4, v2
    v_add_u32 v19, 98304, v15
    v_bfe_u32 v2, v1, 2, 2
    v_lshl_add_u32 v4, v3, 3, v2
    v_lshlrev_b32 v4, 7, v4
    v_lshrrev_b32 v2, 1, v2
    v_lshlrev_b32 v2, 6, v2
    v_and_b32 v20, 3, v1
    v_lshlrev_b32 v20, 3, v20
    v_and_b32 v21, 16, v1
    v_lshl_add_u32 v20, v21, 1, v20
    s_lshl_b32 s25, s7, 6
    v_add_u32 v20, s25, v20
    v_xor_b32 v20, v20, v2
    v_add_u32 v20, v20, v4
    v_add_u32 v20, 32768, v20
    v_add_u32 v21, 49152, v20
    v_add_u32 v22, 98304, v20
    s_mov_b32 s62, 200000
    s_cmp_lg_u32 s3, 0
    s_nop 2
    s_cbranch_scc1 k4_wA_oth
    s_mov_b64 exec, 1
    s_nop 0
k4_wA_poll:
    v_mov_b32 v205, 0
    buffer_atomic_add v205, off, s[56:59], s55 offset:64 sc0
    s_waitcnt vmcnt(0)
    v_readfirstlane_b32 s61, v205
    s_nop 0
    s_cmp_ge_u32 s61, 32
    s_nop 2
    s_cbranch_scc1 k4_wA_pd
    s_sleep 6
    s_sub_u32 s62, s62, 1
    s_cmp_lg_u32 s62, 0
    s_nop 0
    s_cbranch_scc1 k4_wA_poll
    s_nop 0
k4_wA_pd:
    s_mov_b64 exec, -1
    s_nop 0
k4_wA_oth:
    s_barrier
    s_lshl_b32 s28, s32, 15
    s_add_u32 s32, s32, 1
    s_cmp_eq_u32 s32, 10
    s_cselect_b32 s32, 0, s32
    s_add_u32 m0, s26, 0
    s_nop 0
    buffer_load_dwordx4 v8, s[16:19], s28 offen lds
    s_add_u32 m0, s26, 1024
    s_nop 0
    buffer_load_dwordx4 v9, s[16:19], s28 offen lds
    s_add_u32 m0, s26, 2048
    s_nop 0
    buffer_load_dwordx4 v10, s[16:19], s28 offen lds
    s_add_u32 m0, s26, 3072
    s_nop 0
    buffer_load_dwordx4 v11, s[16:19], s28 offen lds
    s_lshl_b32 s28, s32, 15
    s_add_u32 s32, s32, 1
    s_cmp_eq_u32 s32, 10
    s_cselect_b32 s32, 0, s32
    s_add_u32 m0, s26, 49152
    s_nop 0
    buffer_load_dwordx4 v8, s[16:19], s28 offen lds
    s_add_u32 m0, s26, 50176
    s_nop 0
    buffer_load_dwordx4 v9, s[16:19], s28 offen lds
    s_add_u32 m0, s26, 51200
    s_nop 0
    buffer_load_dwordx4 v10, s[16:19], s28 offen lds
    s_add_u32 m0, s26, 52224
    s_nop 0
    buffer_load_dwordx4 v11, s[16:19], s28 offen lds
    s_waitcnt vmcnt(4)
    s_barrier
    ds_read_b64_tr_b16 v[120:121], v20 offset:0
    ds_read_b64_tr_b16 v[122:123], v20 offset:512
    ds_read_b64_tr_b16 v[124:125], v20 offset:8192
    ds_read_b64_tr_b16 v[126:127], v20 offset:8704
    ds_read_b128 v[88:91], v12 offset:0
    ds_read_b128 v[92:95], v12 offset:4096
    ds_read_b64_tr_b16 v[128:129], v20 offset:2048
    ds_read_b64_tr_b16 v[130:131], v20 offset:2560
    ds_read_b64_tr_b16 v[132:133], v20 offset:10240
    ds_read_b64_tr_b16 v[134:135], v20 offset:10752
    ds_read_b128 v[96:99], v13 offset:0
    ds_read_b128 v[100:103], v13 offset:4096
    s_lshl_b32 s28, s32, 15
    s_add_u32 s32, s32, 1
    s_cmp_eq_u32 s32, 10
    s_cselect_b32 s32, 0, s32
    s_mul_i32 s63, s50, 221184
    s_add_u32 s50, s50, 1
    s_cmp_eq_u32 s50, 10
    s_cselect_b32 s50, 0, s50
    s_add_u32 m0, s27, 131072
    s_nop 0
    buffer_load_dwordx4 v6, s[40:43], s63 offen lds
    s_add_u32 m0, s27, 139264
    s_nop 0
    buffer_load_dwordx4 v6, s[44:47], s63 offen lds
    s_add_u32 m0, s26, 98304
    s_nop 0
    buffer_load_dwordx4 v8, s[16:19], s28 offen lds
    s_add_u32 m0, s26, 99328
    s_nop 0
    buffer_load_dwordx4 v9, s[16:19], s28 offen lds
    s_add_u32 m0, s26, 100352
    s_nop 0
    buffer_load_dwordx4 v10, s[16:19], s28 offen lds
    s_add_u32 m0, s26, 101376
    s_nop 0
    buffer_load_dwordx4 v11, s[16:19], s28 offen lds
    s_waitcnt lgkmcnt(6)
    ds_read_b64_tr_b16 v[136:137], v20 offset:4096
    ds_read_b64_tr_b16 v[138:139], v20 offset:4608
    ds_read_b64_tr_b16 v[140:141], v20 offset:12288
    ds_read_b64_tr_b16 v[142:143], v20 offset:12800
    ds_read_b128 v[104:107], v14 offset:0
    ds_read_b128 v[108:111], v14 offset:4096
    s_waitcnt lgkmcnt(6)
    ds_read_b64_tr_b16 v[144:145], v20 offset:6144
    ds_read_b64_tr_b16 v[146:147], v20 offset:6656
    ds_read_b64_tr_b16 v[148:149], v20 offset:14336
    ds_read_b64_tr_b16 v[150:151], v20 offset:14848
    ds_read_b128 v[112:115], v15 offset:0
    ds_read_b128 v[116:119], v15 offset:4096
    v_mfma_f32_32x32x16_bf16 v[24:39], v[120:123], v[88:91], 0
    v_mfma_f32_32x32x16_bf16 v[40:55], v[124:127], v[88:91], 0
    v_mfma_f32_32x32x16_bf16 v[56:71], v[120:123], v[92:95], 0
    v_mfma_f32_32x32x16_bf16 v[72:87], v[124:127], v[92:95], 0
    v_mfma_f32_32x32x16_bf16 v[24:39], v[128:131], v[96:99], v[24:39]
    v_mfma_f32_32x32x16_bf16 v[40:55], v[132:135], v[96:99], v[40:55]
    v_mfma_f32_32x32x16_bf16 v[56:71], v[128:131], v[100:103], v[56:71]
    v_mfma_f32_32x32x16_bf16 v[72:87], v[132:135], v[100:103], v[72:87]
    s_waitcnt lgkmcnt(0)
    s_waitcnt vmcnt(6)
    s_barrier
    s_lshl_b32 s28, s32, 15
    s_add_u32 s32, s32, 1
    s_cmp_eq_u32 s32, 10
    s_cselect_b32 s32, 0, s32
    s_mul_i32 s63, s50, 221184
    s_add_u32 s50, s50, 1
    s_cmp_eq_u32 s50, 10
    s_cselect_b32 s50, 0, s50
    v_mfma_f32_32x32x16_bf16 v[24:39], v[136:139], v[104:107], v[24:39]
    ds_read_b64_tr_b16 v[120:121], v21 offset:0
    ds_read_b64_tr_b16 v[122:123], v21 offset:512
    ds_read_b64_tr_b16 v[124:125], v21 offset:8192
    v_mfma_f32_32x32x16_bf16 v[40:55], v[140:143], v[104:107], v[40:55]
    ds_read_b64_tr_b16 v[126:127], v21 offset:8704
    ds_read_b128 v[88:91], v12 offset:49152
    ds_read_b128 v[92:95], v12 offset:53248
    s_add_u32 m0, s27, 32768
    s_nop 0
    buffer_load_dwordx4 v6, s[40:43], s63 offen lds
    v_mfma_f32_32x32x16_bf16 v[56:71], v[136:139], v[108:111], v[56:71]
    ds_read_b64_tr_b16 v[128:129], v21 offset:2048
    ds_read_b64_tr_b16 v[130:131], v21 offset:2560
    ds_read_b64_tr_b16 v[132:133], v21 offset:10240
    v_mfma_f32_32x32x16_bf16 v[72:87], v[140:143], v[108:111], v[72:87]
    ds_read_b64_tr_b16 v[134:135], v21 offset:10752
    ds_read_b128 v[96:99], v13 offset:49152
    ds_read_b128 v[100:103], v13 offset:53248
    s_add_u32 m0, s27, 40960
    s_nop 0
    buffer_load_dwordx4 v6, s[44:47], s63 offen lds
    s_waitcnt lgkmcnt(6)
    v_mfma_f32_32x32x16_bf16 v[24:39], v[144:147], v[112:115], v[24:39]
    ds_read_b64_tr_b16 v[136:137], v21 offset:4096
    ds_read_b64_tr_b16 v[138:139], v21 offset:4608
    v_mfma_f32_32x32x16_bf16 v[40:55], v[148:151], v[112:115], v[40:55]
    ds_read_b64_tr_b16 v[140:141], v21 offset:12288
    ds_read_b64_tr_b16 v[142:143], v21 offset:12800
    s_add_u32 m0, s26, 0
    s_nop 0
    buffer_load_dwordx4 v8, s[16:19], s28 offen lds
    v_mfma_f32_32x32x16_bf16 v[56:71], v[144:147], v[116:119], v[56:71]
    ds_read_b128 v[104:107], v14 offset:49152
    ds_read_b128 v[108:111], v14 offset:53248
    v_mfma_f32_32x32x16_bf16 v[72:87], v[148:151], v[116:119], v[72:87]
    s_add_u32 m0, s26, 1024
    s_nop 0
    buffer_load_dwordx4 v9, s[16:19], s28 offen lds
    s_waitcnt lgkmcnt(6)
    v_mfma_f32_32x32x16_bf16 v[24:39], v[120:123], v[88:91], v[24:39]
    ds_read_b64_tr_b16 v[144:145], v21 offset:6144
    ds_read_b64_tr_b16 v[146:147], v21 offset:6656
    v_mfma_f32_32x32x16_bf16 v[40:55], v[124:127], v[88:91], v[40:55]
    ds_read_b64_tr_b16 v[148:149], v21 offset:14336
    ds_read_b64_tr_b16 v[150:151], v21 offset:14848
    s_add_u32 m0, s26, 2048
    s_nop 0
    buffer_load_dwordx4 v10, s[16:19], s28 offen lds
    v_mfma_f32_32x32x16_bf16 v[56:71], v[120:123], v[92:95], v[56:71]
    ds_read_b128 v[112:115], v15 offset:49152
    ds_read_b128 v[116:119], v15 offset:53248
    v_mfma_f32_32x32x16_bf16 v[72:87], v[124:127], v[92:95], v[72:87]
    s_add_u32 m0, s26, 3072
    s_nop 0
    buffer_load_dwordx4 v11, s[16:19], s28 offen lds
    v_mfma_f32_32x32x16_bf16 v[24:39], v[128:131], v[96:99], v[24:39]
    v_mfma_f32_32x32x16_bf16 v[40:55], v[132:135], v[96:99], v[40:55]
    v_mfma_f32_32x32x16_bf16 v[56:71], v[128:131], v[100:103], v[56:71]
    v_mfma_f32_32x32x16_bf16 v[72:87], v[132:135], v[100:103], v[72:87]
    s_waitcnt lgkmcnt(0)
    s_waitcnt vmcnt(6)
    s_barrier
    s_lshl_b32 s28, s32, 15
    s_add_u32 s32, s32, 1
    s_cmp_eq_u32 s32, 10
    s_cselect_b32 s32, 0, s32
    s_mul_i32 s63, s50, 221184
    s_add_u32 s50, s50, 1
    s_cmp_eq_u32 s50, 10
    s_cselect_b32 s50, 0, s50
    v_mfma_f32_32x32x16_bf16 v[24:39], v[136:139], v[104:107], v[24:39]
    ds_read_b64_tr_b16 v[120:121], v22 offset:0
    ds_read_b64_tr_b16 v[122:123], v22 offset:512
    ds_read_b64_tr_b16 v[124:125], v22 offset:8192
    v_mfma_f32_32x32x16_bf16 v[40:55], v[140:143], v[104:107], v[40:55]
    ds_read_b64_tr_b16 v[126:127], v22 offset:8704
    ds_read_b128 v[88:91], v16 offset:0
    ds_read_b128 v[92:95], v16 offset:4096
    s_add_u32 m0, s27, 81920
    s_nop 0
    buffer_load_dwordx4 v6, s[40:43], s63 offen lds
    v_mfma_f32_32x32x16_bf16 v[56:71], v[136:139], v[108:111], v[56:71]
    ds_read_b64_tr_b16 v[128:129], v22 offset:2048
    ds_read_b64_tr_b16 v[130:131], v22 offset:2560
    ds_read_b64_tr_b16 v[132:133], v22 offset:10240
    v_mfma_f32_32x32x16_bf16 v[72:87], v[140:143], v[108:111], v[72:87]
    ds_read_b64_tr_b16 v[134:135], v22 offset:10752
    ds_read_b128 v[96:99], v17 offset:0
    ds_read_b128 v[100:103], v17 offset:4096
    s_add_u32 m0, s27, 90112
    s_nop 0
    buffer_load_dwordx4 v6, s[44:47], s63 offen lds
    s_waitcnt lgkmcnt(6)
    v_mfma_f32_32x32x16_bf16 v[24:39], v[144:147], v[112:115], v[24:39]
    ds_read_b64_tr_b16 v[136:137], v22 offset:4096
    ds_read_b64_tr_b16 v[138:139], v22 offset:4608
    v_mfma_f32_32x32x16_bf16 v[40:55], v[148:151], v[112:115], v[40:55]
    ds_read_b64_tr_b16 v[140:141], v22 offset:12288
    ds_read_b64_tr_b16 v[142:143], v22 offset:12800
    s_add_u32 m0, s26, 49152
    s_nop 0
    buffer_load_dwordx4 v8, s[16:19], s28 offen lds
    v_mfma_f32_32x32x16_bf16 v[56:71], v[144:147], v[116:119], v[56:71]
    ds_read_b128 v[104:107], v18 offset:0
    ds_read_b128 v[108:111], v18 offset:4096
    v_mfma_f32_32x32x16_bf16 v[72:87], v[148:151], v[116:119], v[72:87]
    s_add_u32 m0, s26, 50176
    s_nop 0
    buffer_load_dwordx4 v9, s[16:19], s28 offen lds
    s_waitcnt lgkmcnt(6)
    v_mfma_f32_32x32x16_bf16 v[24:39], v[120:123], v[88:91], v[24:39]
    ds_read_b64_tr_b16 v[144:145], v22 offset:6144
    ds_read_b64_tr_b16 v[146:147], v22 offset:6656
    v_mfma_f32_32x32x16_bf16 v[40:55], v[124:127], v[88:91], v[40:55]
    ds_read_b64_tr_b16 v[148:149], v22 offset:14336
    ds_read_b64_tr_b16 v[150:151], v22 offset:14848
    s_add_u32 m0, s26, 51200
    s_nop 0
    buffer_load_dwordx4 v10, s[16:19], s28 offen lds
    v_mfma_f32_32x32x16_bf16 v[56:71], v[120:123], v[92:95], v[56:71]
    ds_read_b128 v[112:115], v19 offset:0
    ds_read_b128 v[116:119], v19 offset:4096
    v_mfma_f32_32x32x16_bf16 v[72:87], v[124:127], v[92:95], v[72:87]
    s_add_u32 m0, s26, 52224
    s_nop 0
    buffer_load_dwordx4 v11, s[16:19], s28 offen lds
    v_mfma_f32_32x32x16_bf16 v[24:39], v[128:131], v[96:99], v[24:39]
    v_mfma_f32_32x32x16_bf16 v[40:55], v[132:135], v[96:99], v[40:55]
    v_mfma_f32_32x32x16_bf16 v[56:71], v[128:131], v[100:103], v[56:71]
    v_mfma_f32_32x32x16_bf16 v[72:87], v[132:135], v[100:103], v[72:87]
    s_waitcnt lgkmcnt(0)
    s_waitcnt vmcnt(6)
    s_barrier
    s_lshl_b32 s28, s32, 15
    s_add_u32 s32, s32, 1
    s_cmp_eq_u32 s32, 10
    s_cselect_b32 s32, 0, s32
    s_mul_i32 s63, s50, 221184
    s_add_u32 s50, s50, 1
    s_cmp_eq_u32 s50, 10
    s_cselect_b32 s50, 0, s50
    v_mfma_f32_32x32x16_bf16 v[24:39], v[136:139], v[104:107], v[24:39]
    ds_read_b64_tr_b16 v[120:121], v20 offset:0
    ds_read_b64_tr_b16 v[122:123], v20 offset:512
    ds_read_b64_tr_b16 v[124:125], v20 offset:8192
    v_mfma_f32_32x32x16_bf16 v[40:55], v[140:143], v[104:107], v[40:55]
    ds_read_b64_tr_b16 v[126:127], v20 offset:8704
    ds_read_b128 v[88:91], v12 offset:0
    ds_read_b128 v[92:95], v12 offset:4096
    s_add_u32 m0, s27, 131072
    s_nop 0
    buffer_load_dwordx4 v6, s[40:43], s63 offen lds
    v_mfma_f32_32x32x16_bf16 v[56:71], v[136:139], v[108:111], v[56:71]
    ds_read_b64_tr_b16 v[128:129], v20 offset:2048
    ds_read_b64_tr_b16 v[130:131], v20 offset:2560
    ds_read_b64_tr_b16 v[132:133], v20 offset:10240
    v_mfma_f32_32x32x16_bf16 v[72:87], v[140:143], v[108:111], v[72:87]
    ds_read_b64_tr_b16 v[134:135], v20 offset:10752
    ds_read_b128 v[96:99], v13 offset:0
    ds_read_b128 v[100:103], v13 offset:4096
    s_add_u32 m0, s27, 139264
    s_nop 0
    buffer_load_dwordx4 v6, s[44:47], s63 offen lds
    s_waitcnt lgkmcnt(6)
    v_mfma_f32_32x32x16_bf16 v[24:39], v[144:147], v[112:115], v[24:39]
    ds_read_b64_tr_b16 v[136:137], v20 offset:4096
    ds_read_b64_tr_b16 v[138:139], v20 offset:4608
    v_mfma_f32_32x32x16_bf16 v[40:55], v[148:151], v[112:115], v[40:55]
    ds_read_b64_tr_b16 v[140:141], v20 offset:12288
    ds_read_b64_tr_b16 v[142:143], v20 offset:12800
    s_add_u32 m0, s26, 98304
    s_nop 0
    buffer_load_dwordx4 v8, s[16:19], s28 offen lds
    v_mfma_f32_32x32x16_bf16 v[56:71], v[144:147], v[116:119], v[56:71]
    ds_read_b128 v[104:107], v14 offset:0
    ds_read_b128 v[108:111], v14 offset:4096
    v_mfma_f32_32x32x16_bf16 v[72:87], v[148:151], v[116:119], v[72:87]
    s_add_u32 m0, s26, 99328
    s_nop 0
    buffer_load_dwordx4 v9, s[16:19], s28 offen lds
    s_waitcnt lgkmcnt(6)
    v_mfma_f32_32x32x16_bf16 v[24:39], v[120:123], v[88:91], v[24:39]
    ds_read_b64_tr_b16 v[144:145], v20 offset:6144
    ds_read_b64_tr_b16 v[146:147], v20 offset:6656
    v_mfma_f32_32x32x16_bf16 v[40:55], v[124:127], v[88:91], v[40:55]
    ds_read_b64_tr_b16 v[148:149], v20 offset:14336
    ds_read_b64_tr_b16 v[150:151], v20 offset:14848
    s_add_u32 m0, s26, 100352
    s_nop 0
    buffer_load_dwordx4 v10, s[16:19], s28 offen lds
    v_mfma_f32_32x32x16_bf16 v[56:71], v[120:123], v[92:95], v[56:71]
    ds_read_b128 v[112:115], v15 offset:0
    ds_read_b128 v[116:119], v15 offset:4096
    v_mfma_f32_32x32x16_bf16 v[72:87], v[124:127], v[92:95], v[72:87]
    s_add_u32 m0, s26, 101376
    s_nop 0
    buffer_load_dwordx4 v11, s[16:19], s28 offen lds
    v_mfma_f32_32x32x16_bf16 v[24:39], v[128:131], v[96:99], v[24:39]
    v_mfma_f32_32x32x16_bf16 v[40:55], v[132:135], v[96:99], v[40:55]
    v_mfma_f32_32x32x16_bf16 v[56:71], v[128:131], v[100:103], v[56:71]
    v_mfma_f32_32x32x16_bf16 v[72:87], v[132:135], v[100:103], v[72:87]
    s_waitcnt lgkmcnt(0)
    s_waitcnt vmcnt(6)
    s_barrier
    s_lshl_b32 s28, s32, 15
    s_add_u32 s32, s32, 1
    s_cmp_eq_u32 s32, 10
    s_cselect_b32 s32, 0, s32
    s_mul_i32 s63, s50, 221184
    s_add_u32 s50, s50, 1
    s_cmp_eq_u32 s50, 10
    s_cselect_b32 s50, 0, s50
    v_mfma_f32_32x32x16_bf16 v[24:39], v[136:139], v[104:107], v[24:39]
    ds_read_b64_tr_b16 v[120:121], v21 offset:0
    ds_read_b64_tr_b16 v[122:123], v21 offset:512
    ds_read_b64_tr_b16 v[124:125], v21 offset:8192
    v_mfma_f32_32x32x16_bf16 v[40:55], v[140:143], v[104:107], v[40:55]
    ds_read_b64_tr_b16 v[126:127], v21 offset:8704
    ds_read_b128 v[88:91], v12 offset:49152
    ds_read_b128 v[92:95], v12 offset:53248
    s_add_u32 m0, s27, 32768
    s_nop 0
    buffer_load_dwordx4 v6, s[40:43], s63 offen lds
    v_mfma_f32_32x32x16_bf16 v[56:71], v[136:139], v[108:111], v[56:71]
    ds_read_b64_tr_b16 v[128:129], v21 offset:2048
    ds_read_b64_tr_b16 v[130:131], v21 offset:2560
    ds_read_b64_tr_b16 v[132:133], v21 offset:10240
    v_mfma_f32_32x32x16_bf16 v[72:87], v[140:143], v[108:111], v[72:87]
    ds_read_b64_tr_b16 v[134:135], v21 offset:10752
    ds_read_b128 v[96:99], v13 offset:49152
    ds_read_b128 v[100:103], v13 offset:53248
    s_add_u32 m0, s27, 40960
    s_nop 0
    buffer_load_dwordx4 v6, s[44:47], s63 offen lds
    s_waitcnt lgkmcnt(6)
    v_mfma_f32_32x32x16_bf16 v[24:39], v[144:147], v[112:115], v[24:39]
    ds_read_b64_tr_b16 v[136:137], v21 offset:4096
    ds_read_b64_tr_b16 v[138:139], v21 offset:4608
    v_mfma_f32_32x32x16_bf16 v[40:55], v[148:151], v[112:115], v[40:55]
    ds_read_b64_tr_b16 v[140:141], v21 offset:12288
    ds_read_b64_tr_b16 v[142:143], v21 offset:12800
    s_add_u32 m0, s26, 0
    s_nop 0
    buffer_load_dwordx4 v8, s[16:19], s28 offen lds
    v_mfma_f32_32x32x16_bf16 v[56:71], v[144:147], v[116:119], v[56:71]
    ds_read_b128 v[104:107], v14 offset:49152
    ds_read_b128 v[108:111], v14 offset:53248
    v_mfma_f32_32x32x16_bf16 v[72:87], v[148:151], v[116:119], v[72:87]
    s_add_u32 m0, s26, 1024
    s_nop 0
    buffer_load_dwordx4 v9, s[16:19], s28 offen lds
    s_waitcnt lgkmcnt(6)
    v_mfma_f32_32x32x16_bf16 v[24:39], v[120:123], v[88:91], v[24:39]
    ds_read_b64_tr_b16 v[144:145], v21 offset:6144
    ds_read_b64_tr_b16 v[146:147], v21 offset:6656
    v_mfma_f32_32x32x16_bf16 v[40:55], v[124:127], v[88:91], v[40:55]
    ds_read_b64_tr_b16 v[148:149], v21 offset:14336
    ds_read_b64_tr_b16 v[150:151], v21 offset:14848
    s_add_u32 m0, s26, 2048
    s_nop 0
    buffer_load_dwordx4 v10, s[16:19], s28 offen lds
    v_mfma_f32_32x32x16_bf16 v[56:71], v[120:123], v[92:95], v[56:71]
    ds_read_b128 v[112:115], v15 offset:49152
    ds_read_b128 v[116:119], v15 offset:53248
    v_mfma_f32_32x32x16_bf16 v[72:87], v[124:127], v[92:95], v[72:87]
    s_add_u32 m0, s26, 3072
    s_nop 0
    buffer_load_dwordx4 v11, s[16:19], s28 offen lds
    v_mfma_f32_32x32x16_bf16 v[24:39], v[128:131], v[96:99], v[24:39]
    v_mfma_f32_32x32x16_bf16 v[40:55], v[132:135], v[96:99], v[40:55]
    v_mfma_f32_32x32x16_bf16 v[56:71], v[128:131], v[100:103], v[56:71]
    v_mfma_f32_32x32x16_bf16 v[72:87], v[132:135], v[100:103], v[72:87]
    s_waitcnt lgkmcnt(0)
    s_waitcnt vmcnt(6)
    s_barrier
    s_lshl_b32 s28, s32, 15
    s_add_u32 s32, s32, 1
    s_cmp_eq_u32 s32, 10
    s_cselect_b32 s32, 0, s32
    s_mul_i32 s63, s50, 221184
    s_add_u32 s50, s50, 1
    s_cmp_eq_u32 s50, 10
    s_cselect_b32 s50, 0, s50
    v_mfma_f32_32x32x16_bf16 v[24:39], v[136:139], v[104:107], v[24:39]
    ds_read_b64_tr_b16 v[120:121], v22 offset:0
    ds_read_b64_tr_b16 v[122:123], v22 offset:512
    ds_read_b64_tr_b16 v[124:125], v22 offset:8192
    v_mfma_f32_32x32x16_bf16 v[40:55], v[140:143], v[104:107], v[40:55]
    ds_read_b64_tr_b16 v[126:127], v22 offset:8704
    ds_read_b128 v[88:91], v16 offset:0
    ds_read_b128 v[92:95], v16 offset:4096
    s_add_u32 m0, s27, 81920
    s_nop 0
    buffer_load_dwordx4 v6, s[40:43], s63 offen lds
    v_mfma_f32_32x32x16_bf16 v[56:71], v[136:139], v[108:111], v[56:71]
    ds_read_b64_tr_b16 v[128:129], v22 offset:2048
    ds_read_b64_tr_b16 v[130:131], v22 offset:2560
    ds_read_b64_tr_b16 v[132:133], v22 offset:10240
    v_mfma_f32_32x32x16_bf16 v[72:87], v[140:143], v[108:111], v[72:87]
    ds_read_b64_tr_b16 v[134:135], v22 offset:10752
    ds_read_b128 v[96:99], v17 offset:0
    ds_read_b128 v[100:103], v17 offset:4096
    s_add_u32 m0, s27, 90112
    s_nop 0
    buffer_load_dwordx4 v6, s[44:47], s63 offen lds
    s_waitcnt lgkmcnt(6)
    v_mfma_f32_32x32x16_bf16 v[24:39], v[144:147], v[112:115], v[24:39]
    ds_read_b64_tr_b16 v[136:137], v22 offset:4096
    ds_read_b64_tr_b16 v[138:139], v22 offset:4608
    v_mfma_f32_32x32x16_bf16 v[40:55], v[148:151], v[112:115], v[40:55]
    ds_read_b64_tr_b16 v[140:141], v22 offset:12288
    ds_read_b64_tr_b16 v[142:143], v22 offset:12800
    s_add_u32 m0, s26, 49152
    s_nop 0
    buffer_load_dwordx4 v8, s[16:19], s28 offen lds
    v_mfma_f32_32x32x16_bf16 v[56:71], v[144:147], v[116:119], v[56:71]
    ds_read_b128 v[104:107], v18 offset:0
    ds_read_b128 v[108:111], v18 offset:4096
    v_mfma_f32_32x32x16_bf16 v[72:87], v[148:151], v[116:119], v[72:87]
    s_add_u32 m0, s26, 50176
    s_nop 0
    buffer_load_dwordx4 v9, s[16:19], s28 offen lds
    s_waitcnt lgkmcnt(6)
    v_mfma_f32_32x32x16_bf16 v[24:39], v[120:123], v[88:91], v[24:39]
    ds_read_b64_tr_b16 v[144:145], v22 offset:6144
    ds_read_b64_tr_b16 v[146:147], v22 offset:6656
    v_mfma_f32_32x32x16_bf16 v[40:55], v[124:127], v[88:91], v[40:55]
    ds_read_b64_tr_b16 v[148:149], v22 offset:14336
    ds_read_b64_tr_b16 v[150:151], v22 offset:14848
    s_add_u32 m0, s26, 51200
    s_nop 0
    buffer_load_dwordx4 v10, s[16:19], s28 offen lds
    v_mfma_f32_32x32x16_bf16 v[56:71], v[120:123], v[92:95], v[56:71]
    ds_read_b128 v[112:115], v19 offset:0
    ds_read_b128 v[116:119], v19 offset:4096
    v_mfma_f32_32x32x16_bf16 v[72:87], v[124:127], v[92:95], v[72:87]
    s_add_u32 m0, s26, 52224
    s_nop 0
    buffer_load_dwordx4 v11, s[16:19], s28 offen lds
    v_mfma_f32_32x32x16_bf16 v[24:39], v[128:131], v[96:99], v[24:39]
    v_mfma_f32_32x32x16_bf16 v[40:55], v[132:135], v[96:99], v[40:55]
    v_mfma_f32_32x32x16_bf16 v[56:71], v[128:131], v[100:103], v[56:71]
    v_mfma_f32_32x32x16_bf16 v[72:87], v[132:135], v[100:103], v[72:87]
    s_waitcnt lgkmcnt(0)
    s_waitcnt vmcnt(6)
    s_barrier
    s_lshl_b32 s28, s32, 15
    s_add_u32 s32, s32, 1
    s_cmp_eq_u32 s32, 10
    s_cselect_b32 s32, 0, s32
    s_mul_i32 s63, s50, 221184
    s_add_u32 s50, s50, 1
    s_cmp_eq_u32 s50, 10
    s_cselect_b32 s50, 0, s50
    v_mfma_f32_32x32x16_bf16 v[24:39], v[136:139], v[104:107], v[24:39]
    ds_read_b64_tr_b16 v[120:121], v20 offset:0
    ds_read_b64_tr_b16 v[122:123], v20 offset:512
    ds_read_b64_tr_b16 v[124:125], v20 offset:8192
    v_mfma_f32_32x32x16_bf16 v[40:55], v[140:143], v[104:107], v[40:55]
    ds_read_b64_tr_b16 v[126:127], v20 offset:8704
    ds_read_b128 v[88:91], v12 offset:0
    ds_read_b128 v[92:95], v12 offset:4096
    s_add_u32 m0, s27, 131072
    s_nop 0
    buffer_load_dwordx4 v6, s[40:43], s63 offen lds
    v_mfma_f32_32x32x16_bf16 v[56:71], v[136:139], v[108:111], v[56:71]
    ds_read_b64_tr_b16 v[128:129], v20 offset:2048
    ds_read_b64_tr_b16 v[130:131], v20 offset:2560
    ds_read_b64_tr_b16 v[132:133], v20 offset:10240
    v_mfma_f32_32x32x16_bf16 v[72:87], v[140:143], v[108:111], v[72:87]
    ds_read_b64_tr_b16 v[134:135], v20 offset:10752
    ds_read_b128 v[96:99], v13 offset:0
    ds_read_b128 v[100:103], v13 offset:4096
    s_add_u32 m0, s27, 139264
    s_nop 0
    buffer_load_dwordx4 v6, s[44:47], s63 offen lds
    s_waitcnt lgkmcnt(6)
    v_mfma_f32_32x32x16_bf16 v[24:39], v[144:147], v[112:115], v[24:39]
    ds_read_b64_tr_b16 v[136:137], v20 offset:4096
    ds_read_b64_tr_b16 v[138:139], v20 offset:4608
    v_mfma_f32_32x32x16_bf16 v[40:55], v[148:151], v[112:115], v[40:55]
    ds_read_b64_tr_b16 v[140:141], v20 offset:12288
    ds_read_b64_tr_b16 v[142:143], v20 offset:12800
    s_add_u32 m0, s26, 98304
    s_nop 0
    buffer_load_dwordx4 v8, s[16:19], s28 offen lds
    v_mfma_f32_32x32x16_bf16 v[56:71], v[144:147], v[116:119], v[56:71]
    ds_read_b128 v[104:107], v14 offset:0
    ds_read_b128 v[108:111], v14 offset:4096
    v_mfma_f32_32x32x16_bf16 v[72:87], v[148:151], v[116:119], v[72:87]
    s_add_u32 m0, s26, 99328
    s_nop 0
    buffer_load_dwordx4 v9, s[16:19], s28 offen lds
    s_waitcnt lgkmcnt(6)
    v_mfma_f32_32x32x16_bf16 v[24:39], v[120:123], v[88:91], v[24:39]
    ds_read_b64_tr_b16 v[144:145], v20 offset:6144
    ds_read_b64_tr_b16 v[146:147], v20 offset:6656
    v_mfma_f32_32x32x16_bf16 v[40:55], v[124:127], v[88:91], v[40:55]
    ds_read_b64_tr_b16 v[148:149], v20 offset:14336
    ds_read_b64_tr_b16 v[150:151], v20 offset:14848
    s_add_u32 m0, s26, 100352
    s_nop 0
    buffer_load_dwordx4 v10, s[16:19], s28 offen lds
    v_mfma_f32_32x32x16_bf16 v[56:71], v[120:123], v[92:95], v[56:71]
    ds_read_b128 v[112:115], v15 offset:0
    ds_read_b128 v[116:119], v15 offset:4096
    v_mfma_f32_32x32x16_bf16 v[72:87], v[124:127], v[92:95], v[72:87]
    s_add_u32 m0, s26, 101376
    s_nop 0
    buffer_load_dwordx4 v11, s[16:19], s28 offen lds
    v_mfma_f32_32x32x16_bf16 v[24:39], v[128:131], v[96:99], v[24:39]
    v_mfma_f32_32x32x16_bf16 v[40:55], v[132:135], v[96:99], v[40:55]
    v_mfma_f32_32x32x16_bf16 v[56:71], v[128:131], v[100:103], v[56:71]
    v_mfma_f32_32x32x16_bf16 v[72:87], v[132:135], v[100:103], v[72:87]
    s_waitcnt lgkmcnt(0)
    s_waitcnt vmcnt(6)
    s_barrier
    s_lshl_b32 s28, s32, 15
    s_add_u32 s32, s32, 1
    s_cmp_eq_u32 s32, 10
    s_cselect_b32 s32, 0, s32
    s_mul_i32 s63, s50, 221184
    s_add_u32 s50, s50, 1
    s_cmp_eq_u32 s50, 10
    s_cselect_b32 s50, 0, s50
    v_mfma_f32_32x32x16_bf16 v[24:39], v[136:139], v[104:107], v[24:39]
    ds_read_b64_tr_b16 v[120:121], v21 offset:0
    ds_read_b64_tr_b16 v[122:123], v21 offset:512
    ds_read_b64_tr_b16 v[124:125], v21 offset:8192
    v_mfma_f32_32x32x16_bf16 v[40:55], v[140:143], v[104:107], v[40:55]
    ds_read_b64_tr_b16 v[126:127], v21 offset:8704
    ds_read_b128 v[88:91], v12 offset:49152
    ds_read_b128 v[92:95], v12 offset:53248
    s_add_u32 m0, s27, 32768
    s_nop 0
    buffer_load_dwordx4 v6, s[40:43], s63 offen lds
    v_mfma_f32_32x32x16_bf16 v[56:71], v[136:139], v[108:111], v[56:71]
    ds_read_b64_tr_b16 v[128:129], v21 offset:2048
    ds_read_b64_tr_b16 v[130:131], v21 offset:2560
    ds_read_b64_tr_b16 v[132:133], v21 offset:10240
    v_mfma_f32_32x32x16_bf16 v[72:87], v[140:143], v[108:111], v[72:87]
    ds_read_b64_tr_b16 v[134:135], v21 offset:10752
    ds_read_b128 v[96:99], v13 offset:49152
    ds_read_b128 v[100:103], v13 offset:53248
    s_add_u32 m0, s27, 40960
    s_nop 0
    buffer_load_dwordx4 v6, s[44:47], s63 offen lds
    s_waitcnt lgkmcnt(6)
    v_mfma_f32_32x32x16_bf16 v[24:39], v[144:147], v[112:115], v[24:39]
    ds_read_b64_tr_b16 v[136:137], v21 offset:4096
    ds_read_b64_tr_b16 v[138:139], v21 offset:4608
    v_mfma_f32_32x32x16_bf16 v[40:55], v[148:151], v[112:115], v[40:55]
    ds_read_b64_tr_b16 v[140:141], v21 offset:12288
    ds_read_b64_tr_b16 v[142:143], v21 offset:12800
    s_add_u32 m0, s26, 0
    s_nop 0
    buffer_load_dwordx4 v8, s[16:19], s28 offen lds
    v_mfma_f32_32x32x16_bf16 v[56:71], v[144:147], v[116:119], v[56:71]
    ds_read_b128 v[104:107], v14 offset:49152
    ds_read_b128 v[108:111], v14 offset:53248
    v_mfma_f32_32x32x16_bf16 v[72:87], v[148:151], v[116:119], v[72:87]
    s_add_u32 m0, s26, 1024
    s_nop 0
    buffer_load_dwordx4 v9, s[16:19], s28 offen lds
    s_waitcnt lgkmcnt(6)
    v_mfma_f32_32x32x16_bf16 v[24:39], v[120:123], v[88:91], v[24:39]
    ds_read_b64_tr_b16 v[144:145], v21 offset:6144
    ds_read_b64_tr_b16 v[146:147], v21 offset:6656
    v_mfma_f32_32x32x16_bf16 v[40:55], v[124:127], v[88:91], v[40:55]
    ds_read_b64_tr_b16 v[148:149], v21 offset:14336
    ds_read_b64_tr_b16 v[150:151], v21 offset:14848
    s_add_u32 m0, s26, 2048
    s_nop 0
    buffer_load_dwordx4 v10, s[16:19], s28 offen lds
    v_mfma_f32_32x32x16_bf16 v[56:71], v[120:123], v[92:95], v[56:71]
    ds_read_b128 v[112:115], v15 offset:49152
    ds_read_b128 v[116:119], v15 offset:53248
    v_mfma_f32_32x32x16_bf16 v[72:87], v[124:127], v[92:95], v[72:87]
    s_add_u32 m0, s26, 3072
    s_nop 0
    buffer_load_dwordx4 v11, s[16:19], s28 offen lds
    v_mfma_f32_32x32x16_bf16 v[24:39], v[128:131], v[96:99], v[24:39]
    v_mfma_f32_32x32x16_bf16 v[40:55], v[132:135], v[96:99], v[40:55]
    v_mfma_f32_32x32x16_bf16 v[56:71], v[128:131], v[100:103], v[56:71]
    v_mfma_f32_32x32x16_bf16 v[72:87], v[132:135], v[100:103], v[72:87]
    s_waitcnt lgkmcnt(0)
    s_waitcnt vmcnt(6)
    s_barrier
    v_mfma_f32_32x32x16_bf16 v[24:39], v[136:139], v[104:107], v[24:39]
    ds_read_b64_tr_b16 v[120:121], v22 offset:0
    ds_read_b64_tr_b16 v[122:123], v22 offset:512
    ds_read_b64_tr_b16 v[124:125], v22 offset:8192
    v_mfma_f32_32x32x16_bf16 v[40:55], v[140:143], v[104:107], v[40:55]
    ds_read_b64_tr_b16 v[126:127], v22 offset:8704
    ds_read_b128 v[88:91], v16 offset:0
    ds_read_b128 v[92:95], v16 offset:4096
    buffer_load_dwordx4 v[156:159], v5, s[8:11], s12 offen offset:0
    v_mfma_f32_32x32x16_bf16 v[56:71], v[136:139], v[108:111], v[56:71]
    ds_read_b64_tr_b16 v[128:129], v22 offset:2048
    ds_read_b64_tr_b16 v[130:131], v22 offset:2560
    ds_read_b64_tr_b16 v[132:133], v22 offset:10240
    v_mfma_f32_32x32x16_bf16 v[72:87], v[140:143], v[108:111], v[72:87]
    ds_read_b64_tr_b16 v[134:135], v22 offset:10752
    ds_read_b128 v[96:99], v17 offset:0
    ds_read_b128 v[100:103], v17 offset:4096
    buffer_load_dwordx4 v[160:163], v5, s[8:11], s12 offen offset:1024
    s_waitcnt lgkmcnt(6)
    v_mfma_f32_32x32x16_bf16 v[24:39], v[144:147], v[112:115], v[24:39]
    ds_read_b64_tr_b16 v[136:137], v22 offset:4096
    ds_read_b64_tr_b16 v[138:139], v22 offset:4608
    v_mfma_f32_32x32x16_bf16 v[40:55], v[148:151], v[112:115], v[40:55]
    ds_read_b64_tr_b16 v[140:141], v22 offset:12288
    ds_read_b64_tr_b16 v[142:143], v22 offset:12800
    buffer_load_dwordx4 v[164:167], v5, s[8:11], s12 offen offset:2048
    v_mfma_f32_32x32x16_bf16 v[56:71], v[144:147], v[116:119], v[56:71]
    ds_read_b128 v[104:107], v18 offset:0
    ds_read_b128 v[108:111], v18 offset:4096
    v_mfma_f32_32x32x16_bf16 v[72:87], v[148:151], v[116:119], v[72:87]
    buffer_load_dwordx4 v[168:171], v5, s[8:11], s12 offen offset:3072
    s_waitcnt lgkmcnt(6)
    v_mfma_f32_32x32x16_bf16 v[24:39], v[120:123], v[88:91], v[24:39]
    ds_read_b64_tr_b16 v[144:145], v22 offset:6144
    ds_read_b64_tr_b16 v[146:147], v22 offset:6656
    v_mfma_f32_32x32x16_bf16 v[40:55], v[124:127], v[88:91], v[40:55]
    ds_read_b64_tr_b16 v[148:149], v22 offset:14336
    ds_read_b64_tr_b16 v[150:151], v22 offset:14848
    buffer_load_dwordx4 v[172:175], v5, s[8:11], s13 offen
    s_add_u32 s12, s12, 10240
    s_cmp_ge_u32 s12, s14
    s_cselect_b32 s12, s15, s12
    s_add_u32 s13, s12, 4096
    v_mfma_f32_32x32x16_bf16 v[56:71], v[120:123], v[92:95], v[56:71]
    ds_read_b128 v[112:115], v19 offset:0
    ds_read_b128 v[116:119], v19 offset:4096
    v_mfma_f32_32x32x16_bf16 v[72:87], v[124:127], v[92:95], v[72:87]
    v_mfma_f32_32x32x16_bf16 v[24:39], v[128:131], v[96:99], v[24:39]
    v_mfma_f32_32x32x16_bf16 v[40:55], v[132:135], v[96:99], v[40:55]
    v_mfma_f32_32x32x16_bf16 v[56:71], v[128:131], v[100:103], v[56:71]
    v_mfma_f32_32x32x16_bf16 v[72:87], v[132:135], v[100:103], v[72:87]
    s_waitcnt lgkmcnt(0)
    s_waitcnt vmcnt(5)
    s_barrier
    v_mfma_f32_32x32x16_bf16 v[24:39], v[136:139], v[104:107], v[24:39]
    ds_read_b64_tr_b16 v[120:121], v20 offset:0
    ds_read_b64_tr_b16 v[122:123], v20 offset:512
    ds_read_b64_tr_b16 v[124:125], v20 offset:8192
    v_mfma_f32_32x32x16_bf16 v[40:55], v[140:143], v[104:107], v[40:55]
    ds_read_b64_tr_b16 v[126:127], v20 offset:8704
    ds_read_b128 v[88:91], v12 offset:0
    ds_read_b128 v[92:95], v12 offset:4096
    s_add_u32 m0, s30, 106496
    s_add_u32 s31, s12, 0
    buffer_load_dwordx4 v5, s[8:11], s31 offen lds
    v_mfma_f32_32x32x16_bf16 v[56:71], v[136:139], v[108:111], v[56:71]
    ds_read_b64_tr_b16 v[128:129], v20 offset:2048
    ds_read_b64_tr_b16 v[130:131], v20 offset:2560
    ds_read_b64_tr_b16 v[132:133], v20 offset:10240
    v_mfma_f32_32x32x16_bf16 v[72:87], v[140:143], v[108:111], v[72:87]
    ds_read_b64_tr_b16 v[134:135], v20 offset:10752
    ds_read_b128 v[96:99], v13 offset:0
    ds_read_b128 v[100:103], v13 offset:4096
    s_add_u32 m0, s30, 107520
    s_add_u32 s31, s12, 1024
    buffer_load_dwordx4 v5, s[8:11], s31 offen lds
    s_waitcnt lgkmcnt(6)
    v_mfma_f32_32x32x16_bf16 v[24:39], v[144:147], v[112:115], v[24:39]
    ds_read_b64_tr_b16 v[136:137], v20 offset:4096
    ds_read_b64_tr_b16 v[138:139], v20 offset:4608
    v_mfma_f32_32x32x16_bf16 v[40:55], v[148:151], v[112:115], v[40:55]
    ds_read_b64_tr_b16 v[140:141], v20 offset:12288
    ds_read_b64_tr_b16 v[142:143], v20 offset:12800
    s_add_u32 m0, s30, 108544
    s_add_u32 s31, s12, 2048
    buffer_load_dwordx4 v5, s[8:11], s31 offen lds
    v_mfma_f32_32x32x16_bf16 v[56:71], v[144:147], v[116:119], v[56:71]
    ds_read_b128 v[104:107], v14 offset:0
    ds_read_b128 v[108:111], v14 offset:4096
    v_mfma_f32_32x32x16_bf16 v[72:87], v[148:151], v[116:119], v[72:87]
    s_add_u32 m0, s30, 109568
    s_add_u32 s31, s12, 3072
    buffer_load_dwordx4 v5, s[8:11], s31 offen lds
    s_waitcnt lgkmcnt(6)
    v_mfma_f32_32x32x16_bf16 v[24:39], v[120:123], v[88:91], v[24:39]
    ds_read_b64_tr_b16 v[144:145], v20 offset:6144
    ds_read_b64_tr_b16 v[146:147], v20 offset:6656
    v_mfma_f32_32x32x16_bf16 v[40:55], v[124:127], v[88:91], v[40:55]
    ds_read_b64_tr_b16 v[148:149], v20 offset:14336
    ds_read_b64_tr_b16 v[150:151], v20 offset:14848
    s_add_u32 m0, s30, 110592
    s_add_u32 s31, s12, 4096
    buffer_load_dwordx4 v5, s[8:11], s31 offen lds
    s_add_u32 s12, s12, 10240
    s_cmp_ge_u32 s12, s14
    s_cselect_b32 s12, s15, s12
    s_add_u32 s13, s12, 4096
    v_mfma_f32_32x32x16_bf16 v[56:71], v[120:123], v[92:95], v[56:71]
    ds_read_b128 v[112:115], v15 offset:0
    ds_read_b128 v[116:119], v15 offset:4096
    v_mfma_f32_32x32x16_bf16 v[72:87], v[124:127], v[92:95], v[72:87]
    v_mfma_f32_32x32x16_bf16 v[24:39], v[128:131], v[96:99], v[24:39]
    v_mfma_f32_32x32x16_bf16 v[40:55], v[132:135], v[96:99], v[40:55]
    v_mfma_f32_32x32x16_bf16 v[56:71], v[128:131], v[100:103], v[56:71]
    v_mfma_f32_32x32x16_bf16 v[72:87], v[132:135], v[100:103], v[72:87]
    s_waitcnt lgkmcnt(0)
    s_barrier
    s_add_u32 m0, s30, 0
    s_add_u32 s31, s12, 0
    buffer_load_dwordx4 v5, s[8:11], s31 offen lds
    v_mfma_f32_32x32x16_bf16 v[24:39], v[136:139], v[104:107], v[24:39]
    v_mfma_f32_32x32x16_bf16 v[40:55], v[140:143], v[104:107], v[40:55]
    s_add_u32 m0, s30, 1024
    s_add_u32 s31, s12, 1024
    buffer_load_dwordx4 v5, s[8:11], s31 offen lds
    v_mfma_f32_32x32x16_bf16 v[56:71], v[136:139], v[108:111], v[56:71]
    v_mfma_f32_32x32x16_bf16 v[72:87], v[140:143], v[108:111], v[72:87]
    s_add_u32 m0, s30, 2048
    s_add_u32 s31, s12, 2048
    buffer_load_dwordx4 v5, s[8:11], s31 offen lds
    v_mfma_f32_32x32x16_bf16 v[24:39], v[144:147], v[112:115], v[24:39]
    v_mfma_f32_32x32x16_bf16 v[40:55], v[148:151], v[112:115], v[40:55]
    s_add_u32 m0, s30, 3072
    s_add_u32 s31, s12, 3072
    buffer_load_dwordx4 v5, s[8:11], s31 offen lds
    v_mfma_f32_32x32x16_bf16 v[56:71], v[144:147], v[116:119], v[56:71]
    v_mfma_f32_32x32x16_bf16 v[72:87], v[148:151], v[116:119], v[72:87]
    s_add_u32 m0, s30, 4096
    s_add_u32 s31, s12, 4096
    buffer_load_dwordx4 v5, s[8:11], s31 offen lds
    s_add_u32 s12, s12, 10240
    s_cmp_ge_u32 s12, s14
    s_cselect_b32 s12, s15, s12
    s_add_u32 s13, s12, 4096
    v_and_b32 v2, 15, v1
    v_lshrrev_b32 v3, 4, v1
    s_mul_i32 s25, s3, 5120
    s_add_u32 s25, s25, 49152
    v_mul_u32_u24 v9, 80, v2
    v_lshl_add_u32 v9, v3, 4, v9
    v_add_u32 v9, s25, v9
    v_and_b32 v2, 31, v1
    v_lshrrev_b32 v3, 5, v1
    v_mul_u32_u24 v8, 80, v2
    v_lshl_add_u32 v8, v3, 3, v8
    v_add_u32 v8, s25, v8
    s_lshl_b32 s24, s4, 2
    s_add_u32 s24, s24, s6
    s_mul_i32 s24, s24, 54
    s_lshl_b32 s25, s5, 1
    s_add_u32 s24, s24, s25
    s_add_u32 s24, s24, s7
    s_lshl_b32 s24, s24, 12
    v_mov_b32 v12, 0xc0135761
    v_mov_b32 v14, 0xbdd2d3e8
    v_mov_b32 v16, 1.0
    v_mov_b32 v13, 0xc0135761
    v_mov_b32 v15, 0xbdd2d3e8
    v_mov_b32 v17, 1.0
    buffer_load_dwordx4 v[176:179], v5, s[8:11], s12 offen offset:0
    v_cvt_pk_bf16_f32 v89, v24, v25
    v_cvt_pk_bf16_f32 v41, v40, v41
    v_lshlrev_b32 v88, 16, v89
    v_and_b32 v89, 0xffff0000, v89
    v_pk_mul_f32 v[90:91], v[88:89], v[88:89]
    v_pk_fma_f32 v[90:91], v[90:91], v[14:15], v[12:13]
    v_pk_mul_f32 v[90:91], v[90:91], v[88:89]
    v_cvt_pk_bf16_f32 v93, v26, v27
    v_cvt_pk_bf16_f32 v43, v42, v43
    v_lshlrev_b32 v92, 16, v93
    v_and_b32 v93, 0xffff0000, v93
    v_pk_mul_f32 v[94:95], v[92:93], v[92:93]
    v_pk_fma_f32 v[94:95], v[94:95], v[14:15], v[12:13]
    v_pk_mul_f32 v[94:95], v[94:95], v[92:93]
    v_cvt_pk_bf16_f32 v97, v28, v29
    v_cvt_pk_bf16_f32 v45, v44, v45
    v_lshlrev_b32 v96, 16, v97
    v_and_b32 v97, 0xffff0000, v97
    v_pk_mul_f32 v[98:99], v[96:97], v[96:97]
    v_pk_fma_f32 v[98:99], v[98:99], v[14:15], v[12:13]
    v_pk_mul_f32 v[98:99], v[98:99], v[96:97]
    v_cvt_pk_bf16_f32 v101, v30, v31
    v_cvt_pk_bf16_f32 v47, v46, v47
    v_lshlrev_b32 v100, 16, v101
    v_and_b32 v101, 0xffff0000, v101
    v_pk_mul_f32 v[102:103], v[100:101], v[100:101]
    v_pk_fma_f32 v[102:103], v[102:103], v[14:15], v[12:13]
    v_pk_mul_f32 v[102:103], v[102:103], v[100:101]
    buffer_load_dwordx4 v[180:183], v5, s[8:11], s12 offen offset:1024
    v_exp_f32 v90, v90
    v_exp_f32 v91, v91
    v_lshlrev_b32 v40, 16, v41
    v_and_b32 v41, 0xffff0000, v41
    v_exp_f32 v94, v94
    v_exp_f32 v95, v95
    v_lshlrev_b32 v42, 16, v43
    v_and_b32 v43, 0xffff0000, v43
    v_exp_f32 v98, v98
    v_exp_f32 v99, v99
    v_lshlrev_b32 v44, 16, v45
    v_and_b32 v45, 0xffff0000, v45
    v_exp_f32 v102, v102
    v_exp_f32 v103, v103
    v_lshlrev_b32 v46, 16, v47
    v_and_b32 v47, 0xffff0000, v47
    buffer_load_dwordx4 v[184:187], v5, s[8:11], s12 offen offset:2048
    v_pk_add_f32 v[90:91], v[90:91], v[16:17]
    v_pk_add_f32 v[94:95], v[94:95], v[16:17]
    v_pk_add_f32 v[98:99], v[98:99], v[16:17]
    v_pk_add_f32 v[102:103], v[102:103], v[16:17]
    buffer_load_dwordx4 v[188:191], v5, s[8:11], s12 offen offset:3072
    v_rcp_f32 v90, v90
    v_rcp_f32 v91, v91
    v_rcp_f32 v94, v94
    v_rcp_f32 v95, v95
    v_rcp_f32 v98, v98
    v_rcp_f32 v99, v99
    v_rcp_f32 v102, v102
    v_rcp_f32 v103, v103
    buffer_load_dwordx4 v[192:195], v5, s[8:11], s13 offen
    s_add_u32 s12, s12, 10240
    s_cmp_ge_u32 s12, s14
    s_cselect_b32 s12, s15, s12
    s_add_u32 s13, s12, 4096
    v_pk_mul_f32 v[88:89], v[88:89], v[90:91]
    v_cvt_pk_bf16_f32 v89, v88, v89
    v_lshlrev_b32 v88, 16, v89
    v_and_b32 v89, 0xffff0000, v89
    v_pk_mul_f32 v[88:89], v[88:89], v[40:41]
    v_cvt_pk_bf16_f32 v120, v88, v89
    v_pk_mul_f32 v[92:93], v[92:93], v[94:95]
    v_cvt_pk_bf16_f32 v93, v92, v93
    v_lshlrev_b32 v92, 16, v93
    v_and_b32 v93, 0xffff0000, v93
    v_pk_mul_f32 v[92:93], v[92:93], v[42:43]
    v_cvt_pk_bf16_f32 v121, v92, v93
    v_pk_mul_f32 v[96:97], v[96:97], v[98:99]
    v_cvt_pk_bf16_f32 v97, v96, v97
    v_lshlrev_b32 v96, 16, v97
    v_and_b32 v97, 0xffff0000, v97
    v_pk_mul_f32 v[96:97], v[96:97], v[44:45]
    v_cvt_pk_bf16_f32 v122, v96, v97
    v_pk_mul_f32 v[100:101], v[100:101], v[102:103]
    v_cvt_pk_bf16_f32 v101, v100, v101
    v_lshlrev_b32 v100, 16, v101
    v_and_b32 v101, 0xffff0000, v101
    v_pk_mul_f32 v[100:101], v[100:101], v[46:47]
    v_cvt_pk_bf16_f32 v123, v100, v101
    ds_write_b64 v8, v[120:121] offset:0
    ds_write_b64 v8, v[122:123] offset:16
    buffer_load_dwordx4 v[196:199], v5, s[8:11], s12 offen offset:0
    v_cvt_pk_bf16_f32 v105, v32, v33
    v_cvt_pk_bf16_f32 v49, v48, v49
    v_lshlrev_b32 v104, 16, v105
    v_and_b32 v105, 0xffff0000, v105
    v_pk_mul_f32 v[106:107], v[104:105], v[104:105]
    v_pk_fma_f32 v[106:107], v[106:107], v[14:15], v[12:13]
    v_pk_mul_f32 v[106:107], v[106:107], v[104:105]
    v_cvt_pk_bf16_f32 v109, v34, v35
    v_cvt_pk_bf16_f32 v51, v50, v51
    v_lshlrev_b32 v108, 16, v109
    v_and_b32 v109, 0xffff0000, v109
    v_pk_mul_f32 v[110:111], v[108:109], v[108:109]
    v_pk_fma_f32 v[110:111], v[110:111], v[14:15], v[12:13]
    v_pk_mul_f32 v[110:111], v[110:111], v[108:109]
    v_cvt_pk_bf16_f32 v113, v36, v37
    v_cvt_pk_bf16_f32 v53, v52, v53
    v_lshlrev_b32 v112, 16, v113
    v_and_b32 v113, 0xffff0000, v113
    v_pk_mul_f32 v[114:115], v[112:113], v[112:113]
    v_pk_fma_f32 v[114:115], v[114:115], v[14:15], v[12:13]
    v_pk_mul_f32 v[114:115], v[114:115], v[112:113]
    v_cvt_pk_bf16_f32 v117, v38, v39
    v_cvt_pk_bf16_f32 v55, v54, v55
    v_lshlrev_b32 v116, 16, v117
    v_and_b32 v117, 0xffff0000, v117
    v_pk_mul_f32 v[118:119], v[116:117], v[116:117]
    v_pk_fma_f32 v[118:119], v[118:119], v[14:15], v[12:13]
    v_pk_mul_f32 v[118:119], v[118:119], v[116:117]
    buffer_load_dwordx4 v[200:203], v5, s[8:11], s12 offen offset:1024
    v_exp_f32 v106, v106
    v_exp_f32 v107, v107
    v_lshlrev_b32 v48, 16, v49
    v_and_b32 v49, 0xffff0000, v49
    v_exp_f32 v110, v110
    v_exp_f32 v111, v111
    v_lshlrev_b32 v50, 16, v51
    v_and_b32 v51, 0xffff0000, v51
    v_exp_f32 v114, v114
    v_exp_f32 v115, v115
    v_lshlrev_b32 v52, 16, v53
    v_and_b32 v53, 0xffff0000, v53
    v_exp_f32 v118, v118
    v_exp_f32 v119, v119
    v_lshlrev_b32 v54, 16, v55
    v_and_b32 v55, 0xffff0000, v55
    buffer_load_dwordx4 v[204:207], v5, s[8:11], s12 offen offset:2048
    v_pk_add_f32 v[106:107], v[106:107], v[16:17]
    v_pk_add_f32 v[110:111], v[110:111], v[16:17]
    v_pk_add_f32 v[114:115], v[114:115], v[16:17]
    v_pk_add_f32 v[118:119], v[118:119], v[16:17]
    buffer_load_dwordx4 v[208:211], v5, s[8:11], s12 offen offset:3072
    v_rcp_f32 v106, v106
    v_rcp_f32 v107, v107
    v_rcp_f32 v110, v110
    v_rcp_f32 v111, v111
    v_rcp_f32 v114, v114
    v_rcp_f32 v115, v115
    v_rcp_f32 v118, v118
    v_rcp_f32 v119, v119
    buffer_load_dwordx4 v[212:215], v5, s[8:11], s13 offen
    s_add_u32 s12, s12, 10240
    s_cmp_ge_u32 s12, s14
    s_cselect_b32 s12, s15, s12
    s_add_u32 s13, s12, 4096
    v_pk_mul_f32 v[104:105], v[104:105], v[106:107]
    v_cvt_pk_bf16_f32 v105, v104, v105
    v_lshlrev_b32 v104, 16, v105
    v_and_b32 v105, 0xffff0000, v105
    v_pk_mul_f32 v[104:105], v[104:105], v[48:49]
    v_cvt_pk_bf16_f32 v124, v104, v105
    v_pk_mul_f32 v[108:109], v[108:109], v[110:111]
    v_cvt_pk_bf16_f32 v109, v108, v109
    v_lshlrev_b32 v108, 16, v109
    v_and_b32 v109, 0xffff0000, v109
    v_pk_mul_f32 v[108:109], v[108:109], v[50:51]
    v_cvt_pk_bf16_f32 v125, v108, v109
    v_pk_mul_f32 v[112:113], v[112:113], v[114:115]
    v_cvt_pk_bf16_f32 v113, v112, v113
    v_lshlrev_b32 v112, 16, v113
    v_and_b32 v113, 0xffff0000, v113
    v_pk_mul_f32 v[112:113], v[112:113], v[52:53]
    v_cvt_pk_bf16_f32 v126, v112, v113
    v_pk_mul_f32 v[116:117], v[116:117], v[118:119]
    v_cvt_pk_bf16_f32 v117, v116, v117
    v_lshlrev_b32 v116, 16, v117
    v_and_b32 v117, 0xffff0000, v117
    v_pk_mul_f32 v[116:117], v[116:117], v[54:55]
    v_cvt_pk_bf16_f32 v127, v116, v117
    ds_write_b64 v8, v[124:125] offset:32
    ds_write_b64 v8, v[126:127] offset:48
    ds_read_b128 v[136:139], v9 offset:0
    ds_read_b128 v[140:143], v9 offset:1280
    v_cvt_pk_bf16_f32 v89, v56, v57
    v_cvt_pk_bf16_f32 v73, v72, v73
    v_lshlrev_b32 v88, 16, v89
    v_and_b32 v89, 0xffff0000, v89
    v_pk_mul_f32 v[90:91], v[88:89], v[88:89]
    v_pk_fma_f32 v[90:91], v[90:91], v[14:15], v[12:13]
    v_pk_mul_f32 v[90:91], v[90:91], v[88:89]
    v_cvt_pk_bf16_f32 v93, v58, v59
    v_cvt_pk_bf16_f32 v75, v74, v75
    v_lshlrev_b32 v92, 16, v93
    v_and_b32 v93, 0xffff0000, v93
    v_pk_mul_f32 v[94:95], v[92:93], v[92:93]
    v_pk_fma_f32 v[94:95], v[94:95], v[14:15], v[12:13]
    v_pk_mul_f32 v[94:95], v[94:95], v[92:93]
    v_cvt_pk_bf16_f32 v97, v60, v61
    v_cvt_pk_bf16_f32 v77, v76, v77
    v_lshlrev_b32 v96, 16, v97
    v_and_b32 v97, 0xffff0000, v97
    v_pk_mul_f32 v[98:99], v[96:97], v[96:97]
    v_pk_fma_f32 v[98:99], v[98:99], v[14:15], v[12:13]
    v_pk_mul_f32 v[98:99], v[98:99], v[96:97]
    v_cvt_pk_bf16_f32 v101, v62, v63
    v_cvt_pk_bf16_f32 v79, v78, v79
    v_lshlrev_b32 v100, 16, v101
    v_and_b32 v101, 0xffff0000, v101
    v_pk_mul_f32 v[102:103], v[100:101], v[100:101]
    v_pk_fma_f32 v[102:103], v[102:103], v[14:15], v[12:13]
    v_pk_mul_f32 v[102:103], v[102:103], v[100:101]
    v_exp_f32 v90, v90
    v_exp_f32 v91, v91
    v_lshlrev_b32 v72, 16, v73
    v_and_b32 v73, 0xffff0000, v73
    v_exp_f32 v94, v94
    v_exp_f32 v95, v95
    v_lshlrev_b32 v74, 16, v75
    v_and_b32 v75, 0xffff0000, v75
    v_exp_f32 v98, v98
    v_exp_f32 v99, v99
    v_lshlrev_b32 v76, 16, v77
    v_and_b32 v77, 0xffff0000, v77
    v_exp_f32 v102, v102
    v_exp_f32 v103, v103
    v_lshlrev_b32 v78, 16, v79
    v_and_b32 v79, 0xffff0000, v79
    v_pk_add_f32 v[90:91], v[90:91], v[16:17]
    v_pk_add_f32 v[94:95], v[94:95], v[16:17]
    v_pk_add_f32 v[98:99], v[98:99], v[16:17]
    v_pk_add_f32 v[102:103], v[102:103], v[16:17]
    v_rcp_f32 v90, v90
    v_rcp_f32 v91, v91
    v_rcp_f32 v94, v94
    v_rcp_f32 v95, v95
    v_rcp_f32 v98, v98
    v_rcp_f32 v99, v99
    v_rcp_f32 v102, v102
    v_rcp_f32 v103, v103
    v_pk_mul_f32 v[88:89], v[88:89], v[90:91]
    v_cvt_pk_bf16_f32 v89, v88, v89
    v_lshlrev_b32 v88, 16, v89
    v_and_b32 v89, 0xffff0000, v89
    v_pk_mul_f32 v[88:89], v[88:89], v[72:73]
    v_cvt_pk_bf16_f32 v128, v88, v89
    v_pk_mul_f32 v[92:93], v[92:93], v[94:95]
    v_cvt_pk_bf16_f32 v93, v92, v93
    v_lshlrev_b32 v92, 16, v93
    v_and_b32 v93, 0xffff0000, v93
    v_pk_mul_f32 v[92:93], v[92:93], v[74:75]
    v_cvt_pk_bf16_f32 v129, v92, v93
    v_pk_mul_f32 v[96:97], v[96:97], v[98:99]
    v_cvt_pk_bf16_f32 v97, v96, v97
    v_lshlrev_b32 v96, 16, v97
    v_and_b32 v97, 0xffff0000, v97
    v_pk_mul_f32 v[96:97], v[96:97], v[76:77]
    v_cvt_pk_bf16_f32 v130, v96, v97
    v_pk_mul_f32 v[100:101], v[100:101], v[102:103]
    v_cvt_pk_bf16_f32 v101, v100, v101
    v_lshlrev_b32 v100, 16, v101
    v_and_b32 v101, 0xffff0000, v101
    v_pk_mul_f32 v[100:101], v[100:101], v[78:79]
    v_cvt_pk_bf16_f32 v131, v100, v101
    ds_write_b64 v8, v[128:129] offset:2560
    ds_write_b64 v8, v[130:131] offset:2576
    s_waitcnt lgkmcnt(2)
    buffer_store_dwordx4 v[136:139], v5, s[20:23], s24 offen offset:0 sc1
    buffer_store_dwordx4 v[140:143], v5, s[20:23], s24 offen offset:1024 sc1
    v_cvt_pk_bf16_f32 v105, v64, v65
    v_cvt_pk_bf16_f32 v81, v80, v81
    v_lshlrev_b32 v104, 16, v105
    v_and_b32 v105, 0xffff0000, v105
    v_pk_mul_f32 v[106:107], v[104:105], v[104:105]
    v_pk_fma_f32 v[106:107], v[106:107], v[14:15], v[12:13]
    v_pk_mul_f32 v[106:107], v[106:107], v[104:105]
    v_cvt_pk_bf16_f32 v109, v66, v67
    v_cvt_pk_bf16_f32 v83, v82, v83
    v_lshlrev_b32 v108, 16, v109
    v_and_b32 v109, 0xffff0000, v109
    v_pk_mul_f32 v[110:111], v[108:109], v[108:109]
    v_pk_fma_f32 v[110:111], v[110:111], v[14:15], v[12:13]
    v_pk_mul_f32 v[110:111], v[110:111], v[108:109]
    v_cvt_pk_bf16_f32 v113, v68, v69
    v_cvt_pk_bf16_f32 v85, v84, v85
    v_lshlrev_b32 v112, 16, v113
    v_and_b32 v113, 0xffff0000, v113
    v_pk_mul_f32 v[114:115], v[112:113], v[112:113]
    v_pk_fma_f32 v[114:115], v[114:115], v[14:15], v[12:13]
    v_pk_mul_f32 v[114:115], v[114:115], v[112:113]
    v_cvt_pk_bf16_f32 v117, v70, v71
    v_cvt_pk_bf16_f32 v87, v86, v87
    v_lshlrev_b32 v116, 16, v117
    v_and_b32 v117, 0xffff0000, v117
    v_pk_mul_f32 v[118:119], v[116:117], v[116:117]
    v_pk_fma_f32 v[118:119], v[118:119], v[14:15], v[12:13]
    v_pk_mul_f32 v[118:119], v[118:119], v[116:117]
    v_exp_f32 v106, v106
    v_exp_f32 v107, v107
    v_lshlrev_b32 v80, 16, v81
    v_and_b32 v81, 0xffff0000, v81
    v_exp_f32 v110, v110
    v_exp_f32 v111, v111
    v_lshlrev_b32 v82, 16, v83
    v_and_b32 v83, 0xffff0000, v83
    v_exp_f32 v114, v114
    v_exp_f32 v115, v115
    v_lshlrev_b32 v84, 16, v85
    v_and_b32 v85, 0xffff0000, v85
    v_exp_f32 v118, v118
    v_exp_f32 v119, v119
    v_lshlrev_b32 v86, 16, v87
    v_and_b32 v87, 0xffff0000, v87
    v_pk_add_f32 v[106:107], v[106:107], v[16:17]
    v_pk_add_f32 v[110:111], v[110:111], v[16:17]
    v_pk_add_f32 v[114:115], v[114:115], v[16:17]
    v_pk_add_f32 v[118:119], v[118:119], v[16:17]
    v_rcp_f32 v106, v106
    v_rcp_f32 v107, v107
    v_rcp_f32 v110, v110
    v_rcp_f32 v111, v111
    v_rcp_f32 v114, v114
    v_rcp_f32 v115, v115
    v_rcp_f32 v118, v118
    v_rcp_f32 v119, v119
    v_pk_mul_f32 v[104:105], v[104:105], v[106:107]
    v_cvt_pk_bf16_f32 v105, v104, v105
    v_lshlrev_b32 v104, 16, v105
    v_and_b32 v105, 0xffff0000, v105
    v_pk_mul_f32 v[104:105], v[104:105], v[80:81]
    v_cvt_pk_bf16_f32 v132, v104, v105
    v_pk_mul_f32 v[108:109], v[108:109], v[110:111]
    v_cvt_pk_bf16_f32 v109, v108, v109
    v_lshlrev_b32 v108, 16, v109
    v_and_b32 v109, 0xffff0000, v109
    v_pk_mul_f32 v[108:109], v[108:109], v[82:83]
    v_cvt_pk_bf16_f32 v133, v108, v109
    v_pk_mul_f32 v[112:113], v[112:113], v[114:115]
    v_cvt_pk_bf16_f32 v113, v112, v113
    v_lshlrev_b32 v112, 16, v113
    v_and_b32 v113, 0xffff0000, v113
    v_pk_mul_f32 v[112:113], v[112:113], v[84:85]
    v_cvt_pk_bf16_f32 v134, v112, v113
    v_pk_mul_f32 v[116:117], v[116:117], v[118:119]
    v_cvt_pk_bf16_f32 v117, v116, v117
    v_lshlrev_b32 v116, 16, v117
    v_and_b32 v117, 0xffff0000, v117
    v_pk_mul_f32 v[116:117], v[116:117], v[86:87]
    v_cvt_pk_bf16_f32 v135, v116, v117
    ds_write_b64 v8, v[132:133] offset:2592
    ds_write_b64 v8, v[134:135] offset:2608
    ds_read_b128 v[144:147], v9 offset:2560
    ds_read_b128 v[148:151], v9 offset:3840
    s_waitcnt lgkmcnt(1)
    buffer_store_dwordx4 v[144:147], v5, s[20:23], s24 offen offset:2048 sc1
    s_waitcnt lgkmcnt(0)
    buffer_store_dwordx4 v[148:151], v5, s[20:23], s24 offen offset:3072 sc1
    s_mov_b32 s54, 1
    s_nop 0
    s_branch k5_start
    s_nop 0
k4_idle:
    s_mov_b32 s54, 0
    buffer_load_dwordx4 v[156:159], v5, s[8:11], s12 offen offset:0
    buffer_load_dwordx4 v[160:163], v5, s[8:11], s12 offen offset:1024
    buffer_load_dwordx4 v[164:167], v5, s[8:11], s12 offen offset:2048
    buffer_load_dwordx4 v[168:171], v5, s[8:11], s12 offen offset:3072
    buffer_load_dwordx4 v[172:175], v5, s[8:11], s13 offen
    s_add_u32 s12, s12, 10240
    s_cmp_ge_u32 s12, s14
    s_cselect_b32 s12, s15, s12
    s_add_u32 s13, s12, 4096
    buffer_load_dwordx4 v[116:119], v5, s[8:11], s12 offen offset:0
    buffer_load_dwordx4 v[120:123], v5, s[8:11], s12 offen offset:1024
    buffer_load_dwordx4 v[124:127], v5, s[8:11], s12 offen offset:2048
    buffer_load_dwordx4 v[128:131], v5, s[8:11], s12 offen offset:3072
    buffer_load_dwordx4 v[132:135], v5, s[8:11], s13 offen
    s_add_u32 s12, s12, 10240
    s_cmp_ge_u32 s12, s14
    s_cselect_b32 s12, s15, s12
    s_add_u32 s13, s12, 4096
    buffer_load_dwordx4 v[136:139], v5, s[8:11], s12 offen offset:0
    buffer_load_dwordx4 v[140:143], v5, s[8:11], s12 offen offset:1024
    buffer_load_dwordx4 v[144:147], v5, s[8:11], s12 offen offset:2048
    buffer_load_dwordx4 v[148:151], v5, s[8:11], s12 offen offset:3072
    buffer_load_dwordx4 v[152:155], v5, s[8:11], s13 offen
    s_add_u32 s12, s12, 10240
    s_cmp_ge_u32 s12, s14
    s_cselect_b32 s12, s15, s12
    s_add_u32 s13, s12, 4096
    buffer_load_dwordx4 v[176:179], v5, s[8:11], s12 offen offset:0
    buffer_load_dwordx4 v[180:183], v5, s[8:11], s12 offen offset:1024
    buffer_load_dwordx4 v[184:187], v5, s[8:11], s12 offen offset:2048
    buffer_load_dwordx4 v[188:191], v5, s[8:11], s12 offen offset:3072
    buffer_load_dwordx4 v[192:195], v5, s[8:11], s13 offen
    s_add_u32 s12, s12, 10240
    s_cmp_ge_u32 s12, s14
    s_cselect_b32 s12, s15, s12
    s_add_u32 s13, s12, 4096
    buffer_load_dwordx4 v[196:199], v5, s[8:11], s12 offen offset:0
    buffer_load_dwordx4 v[200:203], v5, s[8:11], s12 offen offset:1024
    buffer_load_dwordx4 v[204:207], v5, s[8:11], s12 offen offset:2048
    buffer_load_dwordx4 v[208:211], v5, s[8:11], s12 offen offset:3072
    buffer_load_dwordx4 v[212:215], v5, s[8:11], s13 offen
    s_add_u32 s12, s12, 10240
    s_cmp_ge_u32 s12, s14
    s_cselect_b32 s12, s15, s12
    s_add_u32 s13, s12, 4096
    buffer_load_dwordx4 v[216:219], v5, s[8:11], s12 offen offset:0
    buffer_load_dwordx4 v[220:223], v5, s[8:11], s12 offen offset:1024
    buffer_load_dwordx4 v[224:227], v5, s[8:11], s12 offen offset:2048
    buffer_load_dwordx4 v[228:231], v5, s[8:11], s12 offen offset:3072
    buffer_load_dwordx4 v[232:235], v5, s[8:11], s13 offen
    s_add_u32 s12, s12, 10240
    s_cmp_ge_u32 s12, s14
    s_cselect_b32 s12, s15, s12
    s_add_u32 s13, s12, 4096
    buffer_load_dwordx4 v[236:239], v5, s[8:11], s12 offen offset:0
    buffer_load_dwordx4 v[240:243], v5, s[8:11], s12 offen offset:1024
    buffer_load_dwordx4 v[244:247], v5, s[8:11], s12 offen offset:2048
    buffer_load_dwordx4 v[248:251], v5, s[8:11], s12 offen offset:3072
    buffer_load_dwordx4 v[252:255], v5, s[8:11], s13 offen
    s_add_u32 s12, s12, 10240
    s_cmp_ge_u32 s12, s14
    s_cselect_b32 s12, s15, s12
    s_add_u32 s13, s12, 4096
    s_nop 0
k5_start:
    s_load_dwordx2 s[44:45], s[0:1], 56
    s_and_b32 s7, s3, 3
    s_lshr_b32 s31, s3, 2
    s_lshl_b32 s4, s52, 2
    s_and_b32 s5, s53, 3
    s_add_u32 s4, s4, s5
    s_lshl_b32 s32, s5, 1
    s_lshr_b32 s5, s53, 2
    s_mul_i32 s6, s5, 160
    s_lshl_b32 s39, s31, 6
    s_add_u32 s39, s39, s6
    s_add_u32 s24, s7, 0
    s_and_b32 s24, s24, 3
    s_lshl_b32 s24, s24, 10
    v_add_u32 v12, s24, v5
    s_add_u32 s24, s7, 1
    s_and_b32 s24, s24, 3
    s_lshl_b32 s24, s24, 10
    v_add_u32 v13, s24, v5
    s_add_u32 s24, s7, 2
    s_and_b32 s24, s24, 3
    s_lshl_b32 s24, s24, 10
    v_add_u32 v14, s24, v5
    s_add_u32 s24, s7, 3
    s_and_b32 s24, s24, 3
    s_lshl_b32 s24, s24, 10
    v_add_u32 v15, s24, v5
    s_mul_i32 s24, s4, 54
    s_mul_i32 s25, s7, 14
    s_add_u32 s24, s24, s25
    s_add_u32 s24, s24, s31
    s_lshl_b32 s24, s24, 12
    s_mul_i32 s36, s4, 54
    s_add_u32 s36, s36, s31
    s_add_u32 s36, s36, 52
    s_lshl_b32 s36, s36, 12
    s_lshl_b32 s26, s7, 15
    s_lshl_b32 s25, s31, 12
    s_add_u32 s26, s26, s25
    v_add_u32 v8, s26, v5
    v_xor_b32 v9, 0x1000, v8
    s_add_u32 s32, s32, s5
    s_cmp_ge_u32 s32, 7
    s_cselect_b32 s33, 7, 0
    s_sub_u32 s32, s32, s33
    s_lshl_b32 s27, s4, 6
    s_lshl_b32 s28, s7, 4
    s_add_u32 s27, s27, s28
    v_and_b32 v2, 15, v1
    v_lshrrev_b32 v3, 4, v1
    v_add_u32 v2, s27, v2
    v_mul_u32_u24 v2, 1280, v2
    v_lshl_add_u32 v6, v3, 3, v2
    v_add_u32 v4, s30, v5
    v_add_u32 v3, 106496, v4
    s_waitcnt vmcnt(0) lgkmcnt(0)
    s_barrier
    s_cmp_eq_u32 s54, 0
    s_nop 1
    s_cbranch_scc1 k5_nost
    s_cmp_lg_u32 s3, 0
    s_nop 0
    s_cbranch_scc1 k5_aB_na
    s_mov_b64 exec, 1
    v_mov_b32 v2, 1
    buffer_atomic_add v2, off, s[56:59], s55 offset:128
    s_mov_b64 exec, -1
    s_nop 2
k5_aB_na:
    buffer_load_dwordx4 v[216:219], v5, s[8:11], s12 offen offset:0
    buffer_load_dwordx4 v[220:223], v5, s[8:11], s12 offen offset:1024
    buffer_load_dwordx4 v[224:227], v5, s[8:11], s12 offen offset:2048
    buffer_load_dwordx4 v[228:231], v5, s[8:11], s12 offen offset:3072
    buffer_load_dwordx4 v[232:235], v5, s[8:11], s13 offen
    s_add_u32 s12, s12, 10240
    s_cmp_ge_u32 s12, s14
    s_cselect_b32 s12, s15, s12
    s_add_u32 s13, s12, 4096
    buffer_load_dwordx4 v[236:239], v5, s[8:11], s12 offen offset:0
    buffer_load_dwordx4 v[240:243], v5, s[8:11], s12 offen offset:1024
    buffer_load_dwordx4 v[244:247], v5, s[8:11], s12 offen offset:2048
    buffer_load_dwordx4 v[248:251], v5, s[8:11], s12 offen offset:3072
    buffer_load_dwordx4 v[252:255], v5, s[8:11], s13 offen
    s_add_u32 s12, s12, 10240
    s_cmp_ge_u32 s12, s14
    s_cselect_b32 s12, s15, s12
    s_add_u32 s13, s12, 4096
    ds_read_b128 v[116:119], v3 offset:0
    ds_read_b128 v[120:123], v3 offset:1024
    ds_read_b128 v[124:127], v3 offset:2048
    ds_read_b128 v[128:131], v3 offset:3072
    ds_read_b128 v[132:135], v3 offset:4096
    ds_read_b128 v[136:139], v4 offset:0
    ds_read_b128 v[140:143], v4 offset:1024
    ds_read_b128 v[144:147], v4 offset:2048
    ds_read_b128 v[148:151], v4 offset:3072
    ds_read_b128 v[152:155], v4 offset:4096
k5_nost:
    s_add_u32 s16, s48, 0xd00000
    s_addc_u32 s17, s49, 0
    s_mov_b32 s18, 0x6c0000
    s_mov_b32 s19, 0x00020000
    s_add_u32 s20, s48, 0x800000
    s_addc_u32 s21, s49, 0
    s_mov_b32 s22, 0x280000
    s_mov_b32 s23, 0x00020000
    s_mov_b32 s46, 0x280000
    s_mov_b32 s47, 0x00020000
    v_mov_b32 v48, 0
    v_mov_b32 v49, 0
    v_mov_b32 v50, 0
    v_mov_b32 v51, 0
    v_mov_b32 v52, 0
    v_mov_b32 v53, 0
    v_mov_b32 v54, 0
    v_mov_b32 v55, 0
    v_mov_b32 v56, 0
    v_mov_b32 v57, 0
    v_mov_b32 v58, 0
    v_mov_b32 v59, 0
    v_mov_b32 v60, 0
    v_mov_b32 v61, 0
    v_mov_b32 v62, 0
    v_mov_b32 v63, 0
    v_mov_b32 v64, 0
    v_mov_b32 v65, 0
    v_mov_b32 v66, 0
    v_mov_b32 v67, 0
    v_mov_b32 v68, 0
    v_mov_b32 v69, 0
    v_mov_b32 v70, 0
    v_mov_b32 v71, 0
    v_mov_b32 v72, 0
    v_mov_b32 v73, 0
    v_mov_b32 v74, 0
    v_mov_b32 v75, 0
    v_mov_b32 v76, 0
    v_mov_b32 v77, 0
    v_mov_b32 v78, 0
    v_mov_b32 v79, 0
    v_mov_b32 v80, 0
    v_mov_b32 v81, 0
    v_mov_b32 v82, 0
    v_mov_b32 v83, 0
    v_mov_b32 v84, 0
    v_mov_b32 v85, 0
    v_mov_b32 v86, 0
    v_mov_b32 v87, 0
    v_mov_b32 v88, 0
    v_mov_b32 v89, 0
    v_mov_b32 v90, 0
    v_mov_b32 v91, 0
    v_mov_b32 v92, 0
    v_mov_b32 v93, 0
    v_mov_b32 v94, 0
    v_mov_b32 v95, 0
    s_waitcnt lgkmcnt(0)
    s_mov_b32 s62, 200000
    s_cmp_lg_u32 s3, 0
    s_nop 1
    s_cbranch_scc1 k5_wB_oth
    s_mov_b64 exec, 1
    s_nop 0
k5_wB_poll:
    v_mov_b32 v2, 0
    buffer_atomic_add v2, off, s[56:59], s55 offset:128 sc0
    s_waitcnt vmcnt(0)
    v_readfirstlane_b32 s61, v2
    s_nop 0
    s_cmp_ge_u32 s61, 27
    s_nop 2
    s_cbranch_scc1 k5_wB_pd
    s_sleep 6
    s_sub_u32 s62, s62, 1
    s_cmp_lg_u32 s62, 0
    s_nop 0
    s_cbranch_scc1 k5_wB_poll
    s_nop 0
k5_wB_pd:
    s_mov_b64 exec, -1
    s_nop 0
k5_wB_oth:
    s_barrier
    s_lshl_b32 s34, s32, 13
    s_add_u32 s34, s34, s24
    s_min_u32 s34, s34, s36
    s_add_u32 s32, s32, 1
    s_cmp_eq_u32 s32, 7
    s_cselect_b32 s32, 0, s32
    s_add_u32 m0, s26, 0
    s_nop 0
    buffer_load_dwordx4 v12, s[16:19], s34 offen lds
    s_add_u32 m0, s26, 1024
    s_nop 0
    buffer_load_dwordx4 v13, s[16:19], s34 offen lds
    s_add_u32 m0, s26, 2048
    s_nop 0
    buffer_load_dwordx4 v14, s[16:19], s34 offen lds
    s_add_u32 m0, s26, 3072
    s_nop 0
    buffer_load_dwordx4 v15, s[16:19], s34 offen lds
    s_lshl_b32 s34, s32, 13
    s_add_u32 s34, s34, s24
    s_min_u32 s34, s34, s36
    s_add_u32 s32, s32, 1
    s_cmp_eq_u32 s32, 7
    s_cselect_b32 s32, 0, s32
    s_add_u32 m0, s26, 8192
    s_nop 0
    buffer_load_dwordx4 v12, s[16:19], s34 offen lds
    s_add_u32 m0, s26, 9216
    s_nop 0
    buffer_load_dwordx4 v13, s[16:19], s34 offen lds
    s_add_u32 m0, s26, 10240
    s_nop 0
    buffer_load_dwordx4 v14, s[16:19], s34 offen lds
    s_add_u32 m0, s26, 11264
    s_nop 0
    buffer_load_dwordx4 v15, s[16:19], s34 offen lds
    s_waitcnt vmcnt(4)
    s_barrier
    ds_read_b128 v[16:19], v8 offset:0
    ds_read_b128 v[20:23], v8 offset:1024
    ds_read_b128 v[24:27], v8 offset:2048
    ds_read_b128 v[28:31], v8 offset:3072
    s_waitcnt lgkmcnt(0)
    ds_read_b128 v[32:35], v9 offset:0
    ds_read_b128 v[36:39], v9 offset:1024
    ds_read_b128 v[40:43], v9 offset:2048
    ds_read_b128 v[44:47], v9 offset:3072
    v_mfma_f32_16x16x32_bf16 v[48:51], v[156:159], v[16:19], v[48:51]
    v_mfma_f32_16x16x32_bf16 v[64:67], v[160:163], v[16:19], v[64:67]
    v_mfma_f32_16x16x32_bf16 v[80:83], v[164:167], v[16:19], v[80:83]
    s_lshl_b32 s34, s32, 13
    s_add_u32 s34, s34, s24
    s_min_u32 s34, s34, s36
    s_add_u32 s32, s32, 1
    s_cmp_eq_u32 s32, 7
    s_cselect_b32 s32, 0, s32
    s_add_u32 m0, s26, 16384
    s_nop 0
    buffer_load_dwordx4 v12, s[16:19], s34 offen lds
    v_mfma_f32_16x16x32_bf16 v[52:55], v[156:159], v[20:23], v[52:55]
    v_mfma_f32_16x16x32_bf16 v[68:71], v[160:163], v[20:23], v[68:71]
    v_mfma_f32_16x16x32_bf16 v[84:87], v[164:167], v[20:23], v[84:87]
    s_add_u32 m0, s26, 17408
    s_nop 0
    buffer_load_dwordx4 v13, s[16:19], s34 offen lds
    v_mfma_f32_16x16x32_bf16 v[56:59], v[156:159], v[24:27], v[56:59]
    v_mfma_f32_16x16x32_bf16 v[72:75], v[160:163], v[24:27], v[72:75]
    v_mfma_f32_16x16x32_bf16 v[88:91], v[164:167], v[24:27], v[88:91]
    s_add_u32 m0, s26, 18432
    s_nop 0
    buffer_load_dwordx4 v14, s[16:19], s34 offen lds
    v_mfma_f32_16x16x32_bf16 v[60:63], v[156:159], v[28:31], v[60:63]
    v_mfma_f32_16x16x32_bf16 v[76:79], v[160:163], v[28:31], v[76:79]
    v_mfma_f32_16x16x32_bf16 v[92:95], v[164:167], v[28:31], v[92:95]
    s_add_u32 m0, s26, 19456
    s_nop 0
    buffer_load_dwordx4 v15, s[16:19], s34 offen lds
    s_waitcnt vmcnt(4) lgkmcnt(0)
    s_barrier
    ds_read_b128 v[16:19], v8 offset:8192
    ds_read_b128 v[20:23], v8 offset:9216
    ds_read_b128 v[24:27], v8 offset:10240
    ds_read_b128 v[28:31], v8 offset:11264
    v_mfma_f32_16x16x32_bf16 v[48:51], v[168:171], v[32:35], v[48:51]
    v_mfma_f32_16x16x32_bf16 v[64:67], v[172:175], v[32:35], v[64:67]
    s_lshl_b32 s34, s32, 13
    s_add_u32 s34, s34, s24
    s_min_u32 s34, s34, s36
    s_add_u32 s32, s32, 1
    s_cmp_eq_u32 s32, 7
    s_cselect_b32 s32, 0, s32
    s_add_u32 m0, s26, 24576
    s_nop 0
    buffer_load_dwordx4 v12, s[16:19], s34 offen lds
    v_mfma_f32_16x16x32_bf16 v[52:55], v[168:171], v[36:39], v[52:55]
    v_mfma_f32_16x16x32_bf16 v[68:71], v[172:175], v[36:39], v[68:71]
    s_add_u32 m0, s26, 25600
    s_nop 0
    buffer_load_dwordx4 v13, s[16:19], s34 offen lds
    v_mfma_f32_16x16x32_bf16 v[56:59], v[168:171], v[40:43], v[56:59]
    v_mfma_f32_16x16x32_bf16 v[72:75], v[172:175], v[40:43], v[72:75]
    s_add_u32 m0, s26, 26624
    s_nop 0
    buffer_load_dwordx4 v14, s[16:19], s34 offen lds
    v_mfma_f32_16x16x32_bf16 v[60:63], v[168:171], v[44:47], v[60:63]
    v_mfma_f32_16x16x32_bf16 v[76:79], v[172:175], v[44:47], v[76:79]
    s_add_u32 m0, s26, 27648
    s_nop 0
    buffer_load_dwordx4 v15, s[16:19], s34 offen lds
    s_waitcnt lgkmcnt(0)
    ds_read_b128 v[32:35], v9 offset:8192
    ds_read_b128 v[36:39], v9 offset:9216
    ds_read_b128 v[40:43], v9 offset:10240
    ds_read_b128 v[44:47], v9 offset:11264
    v_mfma_f32_16x16x32_bf16 v[48:51], v[116:119], v[16:19], v[48:51]
    v_mfma_f32_16x16x32_bf16 v[64:67], v[120:123], v[16:19], v[64:67]
    v_mfma_f32_16x16x32_bf16 v[80:83], v[124:127], v[16:19], v[80:83]
    v_mfma_f32_16x16x32_bf16 v[52:55], v[116:119], v[20:23], v[52:55]
    v_mfma_f32_16x16x32_bf16 v[68:71], v[120:123], v[20:23], v[68:71]
    v_mfma_f32_16x16x32_bf16 v[84:87], v[124:127], v[20:23], v[84:87]
    v_mfma_f32_16x16x32_bf16 v[56:59], v[116:119], v[24:27], v[56:59]
    v_mfma_f32_16x16x32_bf16 v[72:75], v[120:123], v[24:27], v[72:75]
    v_mfma_f32_16x16x32_bf16 v[88:91], v[124:127], v[24:27], v[88:91]
    v_mfma_f32_16x16x32_bf16 v[60:63], v[116:119], v[28:31], v[60:63]
    v_mfma_f32_16x16x32_bf16 v[76:79], v[120:123], v[28:31], v[76:79]
    v_mfma_f32_16x16x32_bf16 v[92:95], v[124:127], v[28:31], v[92:95]
    s_waitcnt vmcnt(4) lgkmcnt(0)
    s_barrier
    ds_read_b128 v[16:19], v8 offset:16384
    ds_read_b128 v[20:23], v8 offset:17408
    ds_read_b128 v[24:27], v8 offset:18432
    ds_read_b128 v[28:31], v8 offset:19456
    v_mfma_f32_16x16x32_bf16 v[48:51], v[128:131], v[32:35], v[48:51]
    v_mfma_f32_16x16x32_bf16 v[64:67], v[132:135], v[32:35], v[64:67]
    s_lshl_b32 s34, s32, 13
    s_add_u32 s34, s34, s24
    s_min_u32 s34, s34, s36
    s_add_u32 s32, s32, 1
    s_cmp_eq_u32 s32, 7
    s_cselect_b32 s32, 0, s32
    s_add_u32 m0, s26, 0
    s_nop 0
    buffer_load_dwordx4 v12, s[16:19], s34 offen lds
    v_mfma_f32_16x16x32_bf16 v[52:55], v[128:131], v[36:39], v[52:55]
    v_mfma_f32_16x16x32_bf16 v[68:71], v[132:135], v[36:39], v[68:71]
    s_add_u32 m0, s26, 1024
    s_nop 0
    buffer_load_dwordx4 v13, s[16:19], s34 offen lds
    v_mfma_f32_16x16x32_bf16 v[56:59], v[128:131], v[40:43], v[56:59]
    v_mfma_f32_16x16x32_bf16 v[72:75], v[132:135], v[40:43], v[72:75]
    s_add_u32 m0, s26, 2048
    s_nop 0
    buffer_load_dwordx4 v14, s[16:19], s34 offen lds
    v_mfma_f32_16x16x32_bf16 v[60:63], v[128:131], v[44:47], v[60:63]
    v_mfma_f32_16x16x32_bf16 v[76:79], v[132:135], v[44:47], v[76:79]
    s_add_u32 m0, s26, 3072
    s_nop 0
    buffer_load_dwordx4 v15, s[16:19], s34 offen lds
    s_waitcnt lgkmcnt(0)
    ds_read_b128 v[32:35], v9 offset:16384
    ds_read_b128 v[36:39], v9 offset:17408
    ds_read_b128 v[40:43], v9 offset:18432
    ds_read_b128 v[44:47], v9 offset:19456
    v_mfma_f32_16x16x32_bf16 v[48:51], v[136:139], v[16:19], v[48:51]
    v_mfma_f32_16x16x32_bf16 v[64:67], v[140:143], v[16:19], v[64:67]
    v_mfma_f32_16x16x32_bf16 v[80:83], v[144:147], v[16:19], v[80:83]
    v_mfma_f32_16x16x32_bf16 v[52:55], v[136:139], v[20:23], v[52:55]
    v_mfma_f32_16x16x32_bf16 v[68:71], v[140:143], v[20:23], v[68:71]
    v_mfma_f32_16x16x32_bf16 v[84:87], v[144:147], v[20:23], v[84:87]
    v_mfma_f32_16x16x32_bf16 v[56:59], v[136:139], v[24:27], v[56:59]
    v_mfma_f32_16x16x32_bf16 v[72:75], v[140:143], v[24:27], v[72:75]
    v_mfma_f32_16x16x32_bf16 v[88:91], v[144:147], v[24:27], v[88:91]
    v_mfma_f32_16x16x32_bf16 v[60:63], v[136:139], v[28:31], v[60:63]
    v_mfma_f32_16x16x32_bf16 v[76:79], v[140:143], v[28:31], v[76:79]
    v_mfma_f32_16x16x32_bf16 v[92:95], v[144:147], v[28:31], v[92:95]
    s_waitcnt vmcnt(4) lgkmcnt(0)
    s_barrier
    ds_read_b128 v[16:19], v8 offset:24576
    ds_read_b128 v[20:23], v8 offset:25600
    ds_read_b128 v[24:27], v8 offset:26624
    ds_read_b128 v[28:31], v8 offset:27648
    v_mfma_f32_16x16x32_bf16 v[48:51], v[148:151], v[32:35], v[48:51]
    v_mfma_f32_16x16x32_bf16 v[64:67], v[152:155], v[32:35], v[64:67]
    s_lshl_b32 s34, s32, 13
    s_add_u32 s34, s34, s24
    s_min_u32 s34, s34, s36
    s_add_u32 s32, s32, 1
    s_cmp_eq_u32 s32, 7
    s_cselect_b32 s32, 0, s32
    s_add_u32 m0, s26, 8192
    s_nop 0
    buffer_load_dwordx4 v12, s[16:19], s34 offen lds
    v_mfma_f32_16x16x32_bf16 v[52:55], v[148:151], v[36:39], v[52:55]
    v_mfma_f32_16x16x32_bf16 v[68:71], v[152:155], v[36:39], v[68:71]
    s_add_u32 m0, s26, 9216
    s_nop 0
    buffer_load_dwordx4 v13, s[16:19], s34 offen lds
    v_mfma_f32_16x16x32_bf16 v[56:59], v[148:151], v[40:43], v[56:59]
    v_mfma_f32_16x16x32_bf16 v[72:75], v[152:155], v[40:43], v[72:75]
    s_add_u32 m0, s26, 10240
    s_nop 0
    buffer_load_dwordx4 v14, s[16:19], s34 offen lds
    v_mfma_f32_16x16x32_bf16 v[60:63], v[148:151], v[44:47], v[60:63]
    v_mfma_f32_16x16x32_bf16 v[76:79], v[152:155], v[44:47], v[76:79]
    s_add_u32 m0, s26, 11264
    s_nop 0
    buffer_load_dwordx4 v15, s[16:19], s34 offen lds
    s_waitcnt lgkmcnt(0)
    ds_read_b128 v[32:35], v9 offset:24576
    ds_read_b128 v[36:39], v9 offset:25600
    ds_read_b128 v[40:43], v9 offset:26624
    ds_read_b128 v[44:47], v9 offset:27648
    v_mfma_f32_16x16x32_bf16 v[48:51], v[176:179], v[16:19], v[48:51]
    v_mfma_f32_16x16x32_bf16 v[64:67], v[180:183], v[16:19], v[64:67]
    v_mfma_f32_16x16x32_bf16 v[80:83], v[184:187], v[16:19], v[80:83]
    v_mfma_f32_16x16x32_bf16 v[52:55], v[176:179], v[20:23], v[52:55]
    v_mfma_f32_16x16x32_bf16 v[68:71], v[180:183], v[20:23], v[68:71]
    v_mfma_f32_16x16x32_bf16 v[84:87], v[184:187], v[20:23], v[84:87]
    v_mfma_f32_16x16x32_bf16 v[56:59], v[176:179], v[24:27], v[56:59]
    v_mfma_f32_16x16x32_bf16 v[72:75], v[180:183], v[24:27], v[72:75]
    v_mfma_f32_16x16x32_bf16 v[88:91], v[184:187], v[24:27], v[88:91]
    v_mfma_f32_16x16x32_bf16 v[60:63], v[176:179], v[28:31], v[60:63]
    v_mfma_f32_16x16x32_bf16 v[76:79], v[180:183], v[28:31], v[76:79]
    v_mfma_f32_16x16x32_bf16 v[92:95], v[184:187], v[28:31], v[92:95]
    s_waitcnt vmcnt(4) lgkmcnt(0)
    s_barrier
    ds_read_b128 v[16:19], v8 offset:0
    ds_read_b128 v[20:23], v8 offset:1024
    ds_read_b128 v[24:27], v8 offset:2048
    ds_read_b128 v[28:31], v8 offset:3072
    v_mfma_f32_16x16x32_bf16 v[48:51], v[188:191], v[32:35], v[48:51]
    v_mfma_f32_16x16x32_bf16 v[64:67], v[192:195], v[32:35], v[64:67]
    s_lshl_b32 s34, s32, 13
    s_add_u32 s34, s34, s24
    s_min_u32 s34, s34, s36
    s_add_u32 s32, s32, 1
    s_cmp_eq_u32 s32, 7
    s_cselect_b32 s32, 0, s32
    s_add_u32 m0, s26, 16384
    s_nop 0
    buffer_load_dwordx4 v12, s[16:19], s34 offen lds
    v_mfma_f32_16x16x32_bf16 v[52:55], v[188:191], v[36:39], v[52:55]
    v_mfma_f32_16x16x32_bf16 v[68:71], v[192:195], v[36:39], v[68:71]
    s_add_u32 m0, s26, 17408
    s_nop 0
    buffer_load_dwordx4 v13, s[16:19], s34 offen lds
    v_mfma_f32_16x16x32_bf16 v[56:59], v[188:191], v[40:43], v[56:59]
    v_mfma_f32_16x16x32_bf16 v[72:75], v[192:195], v[40:43], v[72:75]
    s_add_u32 m0, s26, 18432
    s_nop 0
    buffer_load_dwordx4 v14, s[16:19], s34 offen lds
    v_mfma_f32_16x16x32_bf16 v[60:63], v[188:191], v[44:47], v[60:63]
    v_mfma_f32_16x16x32_bf16 v[76:79], v[192:195], v[44:47], v[76:79]
    s_add_u32 m0, s26, 19456
    s_nop 0
    buffer_load_dwordx4 v15, s[16:19], s34 offen lds
    s_waitcnt lgkmcnt(0)
    ds_read_b128 v[32:35], v9 offset:0
    ds_read_b128 v[36:39], v9 offset:1024
    ds_read_b128 v[40:43], v9 offset:2048
    ds_read_b128 v[44:47], v9 offset:3072
    v_mfma_f32_16x16x32_bf16 v[48:51], v[196:199], v[16:19], v[48:51]
    v_mfma_f32_16x16x32_bf16 v[64:67], v[200:203], v[16:19], v[64:67]
    v_mfma_f32_16x16x32_bf16 v[80:83], v[204:207], v[16:19], v[80:83]
    v_mfma_f32_16x16x32_bf16 v[52:55], v[196:199], v[20:23], v[52:55]
    v_mfma_f32_16x16x32_bf16 v[68:71], v[200:203], v[20:23], v[68:71]
    v_mfma_f32_16x16x32_bf16 v[84:87], v[204:207], v[20:23], v[84:87]
    v_mfma_f32_16x16x32_bf16 v[56:59], v[196:199], v[24:27], v[56:59]
    v_mfma_f32_16x16x32_bf16 v[72:75], v[200:203], v[24:27], v[72:75]
    v_mfma_f32_16x16x32_bf16 v[88:91], v[204:207], v[24:27], v[88:91]
    v_mfma_f32_16x16x32_bf16 v[60:63], v[196:199], v[28:31], v[60:63]
    v_mfma_f32_16x16x32_bf16 v[76:79], v[200:203], v[28:31], v[76:79]
    v_mfma_f32_16x16x32_bf16 v[92:95], v[204:207], v[28:31], v[92:95]
    s_waitcnt vmcnt(4) lgkmcnt(0)
    s_barrier
    ds_read_b128 v[16:19], v8 offset:8192
    ds_read_b128 v[20:23], v8 offset:9216
    ds_read_b128 v[24:27], v8 offset:10240
    ds_read_b128 v[28:31], v8 offset:11264
    v_mfma_f32_16x16x32_bf16 v[48:51], v[208:211], v[32:35], v[48:51]
    v_mfma_f32_16x16x32_bf16 v[64:67], v[212:215], v[32:35], v[64:67]
    v_mfma_f32_16x16x32_bf16 v[52:55], v[208:211], v[36:39], v[52:55]
    v_mfma_f32_16x16x32_bf16 v[68:71], v[212:215], v[36:39], v[68:71]
    v_mfma_f32_16x16x32_bf16 v[56:59], v[208:211], v[40:43], v[56:59]
    v_mfma_f32_16x16x32_bf16 v[72:75], v[212:215], v[40:43], v[72:75]
    v_mfma_f32_16x16x32_bf16 v[60:63], v[208:211], v[44:47], v[60:63]
    v_mfma_f32_16x16x32_bf16 v[76:79], v[212:215], v[44:47], v[76:79]
    s_waitcnt lgkmcnt(0)
    ds_read_b128 v[32:35], v9 offset:8192
    ds_read_b128 v[36:39], v9 offset:9216
    ds_read_b128 v[40:43], v9 offset:10240
    ds_read_b128 v[44:47], v9 offset:11264
    v_mfma_f32_16x16x32_bf16 v[48:51], v[216:219], v[16:19], v[48:51]
    v_mfma_f32_16x16x32_bf16 v[64:67], v[220:223], v[16:19], v[64:67]
    v_mfma_f32_16x16x32_bf16 v[80:83], v[224:227], v[16:19], v[80:83]
    v_mfma_f32_16x16x32_bf16 v[52:55], v[216:219], v[20:23], v[52:55]
    v_mfma_f32_16x16x32_bf16 v[68:71], v[220:223], v[20:23], v[68:71]
    v_mfma_f32_16x16x32_bf16 v[84:87], v[224:227], v[20:23], v[84:87]
    v_mfma_f32_16x16x32_bf16 v[56:59], v[216:219], v[24:27], v[56:59]
    v_mfma_f32_16x16x32_bf16 v[72:75], v[220:223], v[24:27], v[72:75]
    v_mfma_f32_16x16x32_bf16 v[88:91], v[224:227], v[24:27], v[88:91]
    v_mfma_f32_16x16x32_bf16 v[60:63], v[216:219], v[28:31], v[60:63]
    v_mfma_f32_16x16x32_bf16 v[76:79], v[220:223], v[28:31], v[76:79]
    v_mfma_f32_16x16x32_bf16 v[92:95], v[224:227], v[28:31], v[92:95]
    buffer_load_dwordx2 v[96:97], v6, s[20:23], s39 offen offset:0
    buffer_load_dwordx2 v[98:99], v6, s[20:23], s39 offen offset:32
    buffer_load_dwordx2 v[100:101], v6, s[20:23], s6 offen offset:128
    s_waitcnt vmcnt(3) lgkmcnt(0)
    s_barrier
    ds_read_b128 v[16:19], v8 offset:16384
    ds_read_b128 v[20:23], v8 offset:17408
    ds_read_b128 v[24:27], v8 offset:18432
    ds_read_b128 v[28:31], v8 offset:19456
    v_mfma_f32_16x16x32_bf16 v[48:51], v[228:231], v[32:35], v[48:51]
    v_mfma_f32_16x16x32_bf16 v[64:67], v[232:235], v[32:35], v[64:67]
    v_mfma_f32_16x16x32_bf16 v[52:55], v[228:231], v[36:39], v[52:55]
    v_mfma_f32_16x16x32_bf16 v[68:71], v[232:235], v[36:39], v[68:71]
    v_mfma_f32_16x16x32_bf16 v[56:59], v[228:231], v[40:43], v[56:59]
    v_mfma_f32_16x16x32_bf16 v[72:75], v[232:235], v[40:43], v[72:75]
    v_mfma_f32_16x16x32_bf16 v[60:63], v[228:231], v[44:47], v[60:63]
    v_mfma_f32_16x16x32_bf16 v[76:79], v[232:235], v[44:47], v[76:79]
    s_waitcnt lgkmcnt(0)
    ds_read_b128 v[32:35], v9 offset:16384
    ds_read_b128 v[36:39], v9 offset:17408
    ds_read_b128 v[40:43], v9 offset:18432
    ds_read_b128 v[44:47], v9 offset:19456
    v_mfma_f32_16x16x32_bf16 v[48:51], v[236:239], v[16:19], v[48:51]
    v_mfma_f32_16x16x32_bf16 v[64:67], v[240:243], v[16:19], v[64:67]
    v_mfma_f32_16x16x32_bf16 v[80:83], v[244:247], v[16:19], v[80:83]
    v_mfma_f32_16x16x32_bf16 v[52:55], v[236:239], v[20:23], v[52:55]
    v_mfma_f32_16x16x32_bf16 v[68:71], v[240:243], v[20:23], v[68:71]
    v_mfma_f32_16x16x32_bf16 v[84:87], v[244:247], v[20:23], v[84:87]
    v_mfma_f32_16x16x32_bf16 v[56:59], v[236:239], v[24:27], v[56:59]
    v_mfma_f32_16x16x32_bf16 v[72:75], v[240:243], v[24:27], v[72:75]
    v_mfma_f32_16x16x32_bf16 v[88:91], v[244:247], v[24:27], v[88:91]
    v_mfma_f32_16x16x32_bf16 v[60:63], v[236:239], v[28:31], v[60:63]
    v_mfma_f32_16x16x32_bf16 v[76:79], v[240:243], v[28:31], v[76:79]
    v_mfma_f32_16x16x32_bf16 v[92:95], v[244:247], v[28:31], v[92:95]
    s_waitcnt lgkmcnt(0)
    s_barrier
    v_mfma_f32_16x16x32_bf16 v[48:51], v[248:251], v[32:35], v[48:51]
    v_mfma_f32_16x16x32_bf16 v[64:67], v[252:255], v[32:35], v[64:67]
    v_mfma_f32_16x16x32_bf16 v[52:55], v[248:251], v[36:39], v[52:55]
    v_mfma_f32_16x16x32_bf16 v[68:71], v[252:255], v[36:39], v[68:71]
    v_mfma_f32_16x16x32_bf16 v[56:59], v[248:251], v[40:43], v[56:59]
    v_mfma_f32_16x16x32_bf16 v[72:75], v[252:255], v[40:43], v[72:75]
    v_mfma_f32_16x16x32_bf16 v[60:63], v[248:251], v[44:47], v[60:63]
    v_mfma_f32_16x16x32_bf16 v[76:79], v[252:255], v[44:47], v[76:79]
    s_lshl_b32 s26, s7, 15
    s_lshl_b32 s25, s31, 14
    s_add_u32 s28, s26, s25
    v_add_u32 v8, s28, v5
    s_sub_u32 s28, s7, 1
    s_and_b32 s28, s28, 3
    s_lshl_b32 s28, s28, 15
    s_add_u32 s28, s28, s25
    v_add_u32 v13, s28, v5
    s_sub_u32 s28, s7, 2
    s_and_b32 s28, s28, 3
    s_lshl_b32 s28, s28, 15
    s_add_u32 s28, s28, s25
    v_add_u32 v14, s28, v5
    s_sub_u32 s28, s7, 3
    s_and_b32 s28, s28, 3
    s_lshl_b32 s28, s28, 15
    s_add_u32 s28, s28, s25
    v_add_u32 v15, s28, v5
    ds_write_b128 v8, v[52:55] offset:3072
    ds_write_b128 v8, v[68:71] offset:4096
    ds_write_b128 v8, v[84:87] offset:5120
    ds_write_b128 v8, v[56:59] offset:6144
    ds_write_b128 v8, v[72:75] offset:7168
    ds_write_b128 v8, v[88:91] offset:8192
    ds_write_b128 v8, v[60:63] offset:9216
    ds_write_b128 v8, v[76:79] offset:10240
    ds_write_b128 v8, v[92:95] offset:11264
    ds_write_b128 v8, v[80:83] offset:2048
    s_waitcnt lgkmcnt(0)
    s_barrier
    ds_read_b128 v[52:55], v13 offset:3072
    ds_read_b128 v[68:71], v13 offset:4096
    ds_read_b128 v[56:59], v14 offset:6144
    ds_read_b128 v[72:75], v14 offset:7168
    ds_read_b128 v[60:63], v15 offset:9216
    ds_read_b128 v[76:79], v15 offset:10240
    s_cmp_lg_u32 s31, 0
    s_nop 0
    s_cbranch_scc1 k5_no4
    ds_read_b128 v[84:87], v13 offset:5120
    ds_read_b128 v[88:91], v14 offset:8192
    ds_read_b128 v[92:95], v15 offset:11264
    ds_read_b128 v[16:19], v8 offset:18432
    ds_read_b128 v[20:23], v13 offset:21504
    ds_read_b128 v[24:27], v14 offset:24576
    ds_read_b128 v[28:31], v15 offset:27648
    s_waitcnt lgkmcnt(0)
    v_pk_add_f32 v[80:81], v[80:81], v[16:17]
    v_pk_add_f32 v[82:83], v[82:83], v[18:19]
    v_pk_add_f32 v[84:85], v[84:85], v[20:21]
    v_pk_add_f32 v[86:87], v[86:87], v[22:23]
    v_pk_add_f32 v[88:89], v[88:89], v[24:25]
    v_pk_add_f32 v[90:91], v[90:91], v[26:27]
    v_pk_add_f32 v[92:93], v[92:93], v[28:29]
    v_pk_add_f32 v[94:95], v[94:95], v[30:31]
    s_nop 4
k5_no4:
    s_waitcnt vmcnt(0) lgkmcnt(0)
    v_pk_add_f32 v[48:49], v[48:49], v[52:53]
    v_pk_add_f32 v[50:51], v[50:51], v[54:55]
    v_pk_add_f32 v[48:49], v[48:49], v[56:57]
    v_pk_add_f32 v[50:51], v[50:51], v[58:59]
    v_pk_add_f32 v[48:49], v[48:49], v[60:61]
    v_pk_add_f32 v[50:51], v[50:51], v[62:63]
    v_cvt_pk_bf16_f32 v2, v48, v49
    v_lshlrev_b32 v48, 16, v2
    v_and_b32 v49, 0xffff0000, v2
    v_lshlrev_b32 v2, 16, v96
    v_and_b32 v3, 0xffff0000, v96
    v_add_f32 v48, v48, v2
    v_add_f32 v49, v49, v3
    v_cvt_pk_bf16_f32 v96, v48, v49
    v_cvt_pk_bf16_f32 v2, v50, v51
    v_lshlrev_b32 v50, 16, v2
    v_and_b32 v51, 0xffff0000, v2
    v_lshlrev_b32 v2, 16, v97
    v_and_b32 v3, 0xffff0000, v97
    v_add_f32 v50, v50, v2
    v_add_f32 v51, v51, v3
    v_cvt_pk_bf16_f32 v97, v50, v51
    buffer_store_dwordx2 v[96:97], v6, s[44:47], s39 offen offset:0
    v_pk_add_f32 v[64:65], v[64:65], v[68:69]
    v_pk_add_f32 v[66:67], v[66:67], v[70:71]
    v_pk_add_f32 v[64:65], v[64:65], v[72:73]
    v_pk_add_f32 v[66:67], v[66:67], v[74:75]
    v_pk_add_f32 v[64:65], v[64:65], v[76:77]
    v_pk_add_f32 v[66:67], v[66:67], v[78:79]
    v_cvt_pk_bf16_f32 v2, v64, v65
    v_lshlrev_b32 v64, 16, v2
    v_and_b32 v65, 0xffff0000, v2
    v_lshlrev_b32 v2, 16, v98
    v_and_b32 v3, 0xffff0000, v98
    v_add_f32 v64, v64, v2
    v_add_f32 v65, v65, v3
    v_cvt_pk_bf16_f32 v98, v64, v65
    v_cvt_pk_bf16_f32 v2, v66, v67
    v_lshlrev_b32 v66, 16, v2
    v_and_b32 v67, 0xffff0000, v2
    v_lshlrev_b32 v2, 16, v99
    v_and_b32 v3, 0xffff0000, v99
    v_add_f32 v66, v66, v2
    v_add_f32 v67, v67, v3
    v_cvt_pk_bf16_f32 v99, v66, v67
    buffer_store_dwordx2 v[98:99], v6, s[44:47], s39 offen offset:32
    s_nop 3
    s_cbranch_scc1 k5_fin
    v_pk_add_f32 v[80:81], v[80:81], v[84:85]
    v_pk_add_f32 v[82:83], v[82:83], v[86:87]
    v_pk_add_f32 v[80:81], v[80:81], v[88:89]
    v_pk_add_f32 v[82:83], v[82:83], v[90:91]
    v_pk_add_f32 v[80:81], v[80:81], v[92:93]
    v_pk_add_f32 v[82:83], v[82:83], v[94:95]
    v_cvt_pk_bf16_f32 v2, v80, v81
    v_lshlrev_b32 v80, 16, v2
    v_and_b32 v81, 0xffff0000, v2
    v_lshlrev_b32 v2, 16, v100
    v_and_b32 v3, 0xffff0000, v100
    v_add_f32 v80, v80, v2
    v_add_f32 v81, v81, v3
    v_cvt_pk_bf16_f32 v100, v80, v81
    v_cvt_pk_bf16_f32 v2, v82, v83
    v_lshlrev_b32 v82, 16, v2
    v_and_b32 v83, 0xffff0000, v2
    v_lshlrev_b32 v2, 16, v101
    v_and_b32 v3, 0xffff0000, v101
    v_add_f32 v82, v82, v2
    v_add_f32 v83, v83, v3
    v_cvt_pk_bf16_f32 v101, v82, v83
    buffer_store_dwordx2 v[100:101], v6, s[44:47], s6 offen offset:128
    s_nop 3
k5_fin:
k3_kernel_end:
    s_endpgm
.section .rodata,"a"
.p2align 6
.amdhsa_kernel k1_kernel
  .amdhsa_next_free_vgpr 176
  .amdhsa_next_free_sgpr 96
  .amdhsa_accum_offset 176
  .amdhsa_group_segment_fixed_size 0
  .amdhsa_kernarg_size 80
  .amdhsa_user_sgpr_count 2
  .amdhsa_user_sgpr_kernarg_segment_ptr 1
  .amdhsa_system_sgpr_workgroup_id_x 1
.end_amdhsa_kernel
.p2align 6
.amdhsa_kernel k2_kernel
  .amdhsa_next_free_vgpr 256
  .amdhsa_next_free_sgpr 96
  .amdhsa_accum_offset 256
  .amdhsa_group_segment_fixed_size 0
  .amdhsa_kernarg_size 80
  .amdhsa_user_sgpr_count 2
  .amdhsa_user_sgpr_kernarg_segment_ptr 1
  .amdhsa_system_sgpr_workgroup_id_x 1
.end_amdhsa_kernel
.p2align 6
.amdhsa_kernel k3_kernel
  .amdhsa_next_free_vgpr 256
  .amdhsa_next_free_sgpr 96
  .amdhsa_accum_offset 256
  .amdhsa_group_segment_fixed_size 0
  .amdhsa_kernarg_size 80
  .amdhsa_user_sgpr_count 2
  .amdhsa_user_sgpr_kernarg_segment_ptr 1
  .amdhsa_system_sgpr_workgroup_id_x 1
.end_amdhsa_kernel
```
